```python
import torch

def _softmax(x, axis=-1):
    return torch.softmax(x, dim=axis)

def _gelu(x):
    return torch.nn.functional.gelu(x, approximate='tanh')

def _silu(x):
    return torch.nn.functional.silu(x)

def _sigmoid(x):
    return torch.sigmoid(x)

def _layernorm(x, axis=-1, eps=1e-05):
    m = x.mean(dim=axis, keepdim=True)
    v = x.var(dim=axis, keepdim=True, unbiased=False)
    return (x - m) / torch.sqrt(v + eps)

def _scatter_add(tgt, idx, src, axis=0):
    return tgt.clone().index_add_(axis, idx, src)

def _segment_sum(src, seg, n):
    out = torch.zeros((n,) + src.shape[1:], dtype=src.dtype)
    return out.index_add_(0, seg, src)

def _pad(x, pw):
    flat = tuple((v for pair in reversed(pw) for v in pair))
    return torch.nn.functional.pad(x, flat)
kernel_name = 'adaLN_cond__gqa_block_cached__dense_activation_squared_relu__decode'

def setup_inputs():

    _w = lambda a: (lambda t: t.to(torch.bfloat16) if t.is_floating_point() else t)(torch.as_tensor(a))

    def _A_setup():
        B, Sq, D = (2, 1, 576)
        Hq, Hkv, Sk, Dh = (32, 16, 8192, 128)
        assert Hq % Hkv == 0, (Hq, Hkv)
        return {'x': _w((lambda *s: torch.randn(*s, dtype=torch.bfloat16) * 0.05)(B, Sq, D)), 'k_cache': _w((lambda *s: torch.randn(*s, dtype=torch.bfloat16) * 3.2)(B, Hkv, Sk, Dh)), 'v_cache': _w((lambda *s: torch.randn(*s, dtype=torch.bfloat16) * 0.4)(B, Hkv, Sk, Dh)), 'wq': _w((lambda *s: torch.randn(*s, dtype=torch.bfloat16) * 3.2)(D, Hq * Dh) * D ** (-0.5)), 'wo': _w((lambda *s: torch.randn(*s, dtype=torch.bfloat16) * 0.4)(Hq * Dh, D) * (Hq * Dh) ** (-0.5))}
    _A_in = _A_setup()

    def _B_setup():
        B, S, D, F = (2, 1, 576, 4608)
        return {'x': _w((lambda *s: torch.randn(*s, dtype=torch.bfloat16) * 0.05)(B, S, D)), 'w1': _w((lambda *s: torch.randn(*s, dtype=torch.bfloat16) * 0.05)(D, F)), 'b1': _w((lambda *s: torch.randn(*s, dtype=torch.bfloat16) * 0.4)(F)), 'w2': _w((lambda *s: torch.randn(*s, dtype=torch.bfloat16) * 0.05)(F, D)), 'b2': _w((lambda *s: torch.randn(*s, dtype=torch.bfloat16) * 3.2)(D))}
    _B_in = _B_setup()
    return {'A_x': _A_in['x'], 'A_k_cache': _A_in['k_cache'], 'A_v_cache': _A_in['v_cache'], 'A_wq': _A_in['wq'], 'A_wo': _A_in['wo'], 'B_x': _B_in['x'], 'B_w1': _B_in['w1'], 'B_b1': _B_in['b1'], 'B_w2': _B_in['w2'], 'B_b2': _B_in['b2'], 'c': _w((lambda *s: torch.randn(*s, dtype=torch.bfloat16) * 0.1)(2, 576) * 8.0), 'w_mod': _w((lambda *s: torch.randn(*s, dtype=torch.bfloat16) * 0.1)(576, 6 * 576) * 576 ** (-0.5) * 8.0)}

def reference(A_x, A_k_cache, A_v_cache, A_wq, A_wo, B_x, B_w1, B_b1, B_w2, B_b2, c, w_mod):

    def _A_ref(x, k_cache, v_cache, wq, wo):
        B, Sq, D = x.shape
        Hq, Dh = (32, 128)
        Hkv = k_cache.shape[1]
        rep = Hq // Hkv
        q = (lambda x, *d: x.permute(*d))((x @ wq).reshape(B, Sq, Hq, Dh), 0, 2, 1, 3)
        k = (lambda x, n, axis: torch.repeat_interleave(x, n, dim=axis))(k_cache, rep, axis=1)
        v = (lambda x, n, axis: torch.repeat_interleave(x, n, dim=axis))(v_cache, rep, axis=1)
        scores = torch.einsum('bhqd,bhkd->bhqk', q, k) * Dh ** (-0.5)
        p = _softmax(scores, axis=-1)
        o = torch.einsum('bhqk,bhkd->bhqd', p, v)
        return (lambda x, *d: x.permute(*d))(o, 0, 2, 1, 3).reshape(B, Sq, Hq * Dh) @ wo

    def _B_ref(x, w1, b1, w2, b2):
        h = torch.einsum('bsd,df->bsf', x, w1) + b1
        zero = torch.zeros_like(h)
        r = torch.where(h > zero, h, zero)
        h = r * r
        out = torch.einsum('bsf,fd->bsd', h, w2) + b2
        return out
    x = A_x
    mod = (_silu(c) @ w_mod).reshape(c.shape[0], 6, 1, -1)
    sa, ca, ga, sb, cb, gb = (mod[:, 0].clone(), mod[:, 1].clone(), mod[:, 2].clone(), mod[:, 3].clone(), mod[:, 4].clone(), mod[:, 5].clone())
    h = _layernorm(x, axis=-1) * (1 + ca) + sa
    x = x + ga * _A_ref(h, A_k_cache, A_v_cache, A_wq, A_wo)
    h = _layernorm(x, axis=-1) * (1 + cb) + sb
    x = x + gb * _B_ref(h, B_w1, B_b1, B_w2, B_b2)
    return x
```

```asm
; @launch grid=(256,1,1) block=(768,1,1) lds=155648
.amdgcn_target "amdgcn-amd-amdhsa--gfx950"
.text
.globl adaLN_cond__gqa_block_cached__dense_activation_squared_relu__decode_kernel
.p2align 8
.type adaLN_cond__gqa_block_cached__dense_activation_squared_relu__decode_kernel,@function
adaLN_cond__gqa_block_cached__dense_activation_squared_relu__decode_kernel:
    s_cmp_ge_u32 s2, 256
    s_cbranch_scc1 L_end
    s_load_dwordx16 s[36:51], s[0:1], 0
    s_load_dwordx8 s[52:59], s[0:1], 64
    s_load_dwordx4 s[60:63], s[0:1], 96
    s_load_dwordx2 s[64:65], s[0:1], 112
    s_getpc_b64 s[66:67]
L_pc0:
    s_lshl_b32 s68, s2, 2
    s_add_u32 s66, s66, L_table-L_pc0
    s_addc_u32 s67, s67, 0
    s_load_dword s100, s[66:67], s68
    v_lshrrev_b32 v2, 6, v0
    v_and_b32 v1, 63, v0
    v_readfirstlane_b32 s3, v2
    v_mov_b32 v0, 0
    s_cmp_lg_u32 s3, 0
    s_nop 1
    s_cbranch_scc1 L_noinit0
    v_lshlrev_b32 v2, 2, v1
    ds_write_b32 v2, v0
    s_waitcnt lgkmcnt(0)
L_noinit0:
    s_cmp_lt_u32 s3, 4
    s_cbranch_scc1 L_chain
L_stream:
    s_setprio 1
    s_sub_u32 s3, s3, 4
    v_and_b32 v2, 3, v1
    v_lshlrev_b32 v2, 4, v2
    v_bfe_u32 v3, v1, 2, 2
    v_lshl_add_u32 v2, v3, 8, v2
    v_lshrrev_b32 v3, 4, v1
    v_lshl_add_u32 v2, v3, 6, v2
    v_lshlrev_b32 v3, 4, v1
    v_and_b32 v18, 3, v1
    v_lshlrev_b32 v18, 4, v18
    v_bfe_u32 v17, v1, 2, 1
    v_lshl_add_u32 v18, v17, 8, v18
    v_lshrrev_b32 v17, 4, v1
    v_lshl_add_u32 v18, v17, 6, v18
    s_and_b32 s34, s2, 31
    s_lshl_b32 s70, s34, 21
    s_lshl_b32 s34, s34, 3
    s_lshr_b32 s35, s2, 5
    s_add_u32 s34, s34, s35
    s_lshl_b32 s34, s34, 10
    s_add_u32 s34, s34, 65536
    s_lshl_b32 s35, s3, 14
    s_add_u32 s35, s35, 24576
    s_waitcnt lgkmcnt(0)
    s_and_b32 s71, s100, 0xff
    s_lshl_b32 s71, s71, 13
    s_add_u32 s70, s70, s71
    s_bfe_u32 s27, s100, 0x40008
    s_mov_b32 s72, s70
    s_lshl_b32 s71, s3, 12
    s_add_u32 s70, s70, s71
    s_mov_b32 s4, s38
    s_and_b32 s5, s39, 0xffff
    s_mov_b32 s6, 67108864
    s_mov_b32 s7, 0x00020000
    s_mov_b32 s8, s40
    s_and_b32 s9, s41, 0xffff
    s_mov_b32 s10, 67108864
    s_mov_b32 s11, 0x00020000
    s_mov_b32 s12, s64
    s_and_b32 s13, s65, 0xffff
    s_mov_b32 s14, 268435456
    s_mov_b32 s15, 0x00020000
L_kf0:
    s_add_u32 s71, s70, 0
    buffer_load_dwordx4 v[26:29], v2, s[4:7], s71 offen nt
L_kf1:
    s_add_u32 s71, s70, 1024
    buffer_load_dwordx4 v[30:33], v2, s[4:7], s71 offen nt
L_kf2:
    s_add_u32 s71, s70, 2048
    buffer_load_dwordx4 v[34:37], v2, s[4:7], s71 offen nt
L_kf3:
    s_add_u32 s71, s70, 3072
    buffer_load_dwordx4 v[38:41], v2, s[4:7], s71 offen nt
    s_add_u32 s73, s27, 2
    s_and_b32 s74, s73, 3
    s_mul_i32 s74, s74, s3
    s_lshl_b32 s74, s74, 10
    s_add_u32 s72, s72, s74
    s_cmp_ge_u32 s73, 4
    s_cselect_b32 s74, s70, s72
    s_add_u32 s16, s74, 196608
    s_add_u32 s17, s74, 197632
    s_add_u32 s18, s74, 198656
    s_add_u32 s19, s74, 199680
    s_cmp_ge_u32 s73, 8
    s_cselect_b32 s74, s70, s72
    s_add_u32 s20, s74, 229376
    s_add_u32 s21, s74, 230400
    s_add_u32 s22, s74, 231424
    s_add_u32 s23, s74, 232448
    s_cmp_ge_u32 s73, 12
    s_cselect_b32 s74, s70, s72
    s_add_u32 s24, s74, 262144
    s_add_u32 s25, s74, 263168
    s_add_u32 s26, s74, 264192
    s_cmp_gt_u32 s27, 0
    s_cselect_b32 s18, s18, 0x80000000
    s_cselect_b32 s40, 1145324612, 0
    s_mov_b32 s41, s40
    s_cmp_gt_u32 s27, 1
    s_cselect_b32 s19, s19, 0x80000000
    s_cselect_b32 s42, 2290649224, 0
    s_mov_b32 s43, s42
    s_cmp_gt_u32 s27, 2
    s_cselect_b32 s20, s20, 0x80000000
    s_cselect_b32 s44, 286331153, 0
    s_mov_b32 s45, s44
    s_cmp_gt_u32 s27, 3
    s_cselect_b32 s21, s21, 0x80000000
    s_cselect_b32 s46, 572662306, 0
    s_mov_b32 s47, s46
    s_cmp_gt_u32 s27, 4
    s_cselect_b32 s22, s22, 0x80000000
    s_cselect_b32 s48, 1145324612, 0
    s_mov_b32 s49, s48
    s_cmp_gt_u32 s27, 5
    s_cselect_b32 s23, s23, 0x80000000
    s_cselect_b32 s50, 2290649224, 0
    s_mov_b32 s51, s50
    s_cmp_gt_u32 s27, 6
    s_cselect_b32 s24, s24, 0x80000000
    s_cselect_b32 s52, 286331153, 0
    s_mov_b32 s53, s52
    s_cmp_gt_u32 s27, 7
    s_cselect_b32 s25, s25, 0x80000000
    s_cselect_b32 s54, 572662306, 0
    s_mov_b32 s55, s54
    s_cmp_gt_u32 s27, 8
    s_cselect_b32 s26, s26, 0x80000000
    s_cselect_b32 s56, 1145324612, 0
    s_mov_b32 s57, s56
    s_mov_b32 s58, 286331153
    s_mov_b32 s59, 286331153
    s_mov_b32 s60, 572662306
    s_mov_b32 s61, 572662306
    s_mov_b32 s62, 1145324612
    s_mov_b32 s63, 1145324612
    s_mov_b32 s64, 2290649224
    s_mov_b32 s65, 2290649224
    v_mov_b32 v14, 0xff800000
    v_mov_b32 v15, 0xff800000
    v_mov_b32 v16, 0xff800000
    s_barrier
L_kf4:
    s_waitcnt vmcnt(3)
    s_add_u32 s71, s70, 32768
    buffer_load_dwordx4 v[42:45], v2, s[4:7], s71 offen nt
L_kf5:
    s_waitcnt vmcnt(3)
    s_add_u32 s71, s70, 33792
    buffer_load_dwordx4 v[46:49], v2, s[4:7], s71 offen nt
L_kf6:
    s_waitcnt vmcnt(3)
    s_add_u32 s71, s70, 34816
    buffer_load_dwordx4 v[50:53], v2, s[4:7], s71 offen nt
L_kf7:
    s_waitcnt vmcnt(3)
    s_add_u32 s71, s70, 35840
    buffer_load_dwordx4 v[54:57], v2, s[4:7], s71 offen nt
L_kf8:
    s_waitcnt vmcnt(3)
    s_add_u32 s71, s70, 65536
    buffer_load_dwordx4 v[58:61], v2, s[4:7], s71 offen nt
L_kf9:
    s_waitcnt vmcnt(3)
    s_add_u32 s71, s70, 66560
    buffer_load_dwordx4 v[62:65], v2, s[4:7], s71 offen nt
L_kf10:
    s_waitcnt vmcnt(3)
    s_add_u32 s71, s70, 67584
    buffer_load_dwordx4 v[66:69], v2, s[4:7], s71 offen nt
L_kf11:
    s_waitcnt vmcnt(3)
    s_add_u32 s71, s70, 68608
    buffer_load_dwordx4 v[70:73], v2, s[4:7], s71 offen nt
L_kf12:
    s_waitcnt vmcnt(3)
    s_add_u32 s71, s70, 98304
    buffer_load_dwordx4 v[74:77], v2, s[4:7], s71 offen nt
L_kf13:
    s_waitcnt vmcnt(3)
    s_add_u32 s71, s70, 99328
    buffer_load_dwordx4 v[78:81], v2, s[4:7], s71 offen nt
L_kf14:
    s_waitcnt vmcnt(3)
    s_add_u32 s71, s70, 100352
    buffer_load_dwordx4 v[82:85], v2, s[4:7], s71 offen nt
L_kf15:
    s_waitcnt vmcnt(3)
    s_add_u32 s71, s70, 101376
    buffer_load_dwordx4 v[86:89], v2, s[4:7], s71 offen nt
L_kf16:
    s_waitcnt vmcnt(3)
    s_add_u32 s71, s70, 131072
    buffer_load_dwordx4 v[90:93], v2, s[4:7], s71 offen nt
L_kf17:
    s_waitcnt vmcnt(3)
    s_add_u32 s71, s70, 132096
    buffer_load_dwordx4 v[94:97], v2, s[4:7], s71 offen nt
L_kf18:
    s_waitcnt vmcnt(3)
    s_add_u32 s71, s70, 133120
    buffer_load_dwordx4 v[98:101], v2, s[4:7], s71 offen nt
L_kf19:
    s_waitcnt vmcnt(3)
    s_add_u32 s71, s70, 134144
    buffer_load_dwordx4 v[102:105], v2, s[4:7], s71 offen nt
L_kf20:
    s_waitcnt vmcnt(3)
    s_add_u32 s71, s70, 163840
    buffer_load_dwordx4 v[106:109], v2, s[4:7], s71 offen nt
L_kf21:
    s_waitcnt vmcnt(3)
    s_add_u32 s71, s70, 164864
    buffer_load_dwordx4 v[110:113], v2, s[4:7], s71 offen nt
L_kf22:
    s_waitcnt vmcnt(3)
    s_add_u32 s71, s70, 165888
    buffer_load_dwordx4 v[114:117], v2, s[4:7], s71 offen nt
L_kf23:
    s_waitcnt vmcnt(3)
    s_add_u32 s71, s70, 166912
    buffer_load_dwordx4 v[118:121], v2, s[4:7], s71 offen nt
L_kf24:
    s_waitcnt vmcnt(3)
    buffer_load_dwordx4 v[122:125], v2, s[4:7], s16 offen nt
L_kf25:
    s_waitcnt vmcnt(3)
    buffer_load_dwordx4 v[126:129], v2, s[4:7], s17 offen nt
L_kf26:
    s_waitcnt vmcnt(3)
    buffer_load_dwordx4 v[130:133], v2, s[4:7], s18 offen nt
L_kf27:
    s_waitcnt vmcnt(3)
    buffer_load_dwordx4 v[134:137], v2, s[4:7], s19 offen nt
L_kf28:
    s_waitcnt vmcnt(3)
    buffer_load_dwordx4 v[138:141], v2, s[4:7], s20 offen nt
L_kf29:
    s_waitcnt vmcnt(3)
    buffer_load_dwordx4 v[142:145], v2, s[4:7], s21 offen nt
L_kf30:
    s_waitcnt vmcnt(3)
    buffer_load_dwordx4 v[146:149], v2, s[4:7], s22 offen nt
L_kf31:
    s_waitcnt vmcnt(3)
    buffer_load_dwordx4 v[150:153], v2, s[4:7], s23 offen nt
L_kf32:
    s_waitcnt vmcnt(3)
    buffer_load_dwordx4 v[154:157], v2, s[4:7], s24 offen nt
L_kf33:
    s_waitcnt vmcnt(3)
    buffer_load_dwordx4 v[158:161], v2, s[4:7], s25 offen nt
L_kf34:
    s_waitcnt vmcnt(3)
    buffer_load_dwordx4 v[162:165], v2, s[4:7], s26 offen nt
L_kf35:
    s_waitcnt lgkmcnt(0)
    v_mov_b32 v17, 1
    s_mov_b64 exec, 1
    ds_add_u32 v0, v17 offset:44
    s_mov_b64 exec, -1
    s_setprio 0
    s_mov_b32 s80, 0
SP_108:
    ds_read_b32 v17, v0 offset:44
    s_waitcnt lgkmcnt(0)
    v_readfirstlane_b32 s81, v17
    s_cmp_ge_u32 s81, 8
    s_nop 2
    s_cbranch_scc1 SPD_109
    s_add_u32 s80, s80, 1
    s_cmp_gt_u32 s80, 100000
    s_cbranch_scc1 SPD_109
    s_sleep 4
    s_branch SP_108
SPD_109:
    s_add_u32 m0, s35, 0
    s_add_u32 s71, s70, 0
    buffer_load_dwordx4 v3, s[8:11], s71 offen nt lds
    s_add_u32 m0, s35, 1024
    s_add_u32 s71, s70, 1024
    buffer_load_dwordx4 v3, s[8:11], s71 offen nt lds
    s_add_u32 m0, s35, 2048
    s_add_u32 s71, s70, 2048
    buffer_load_dwordx4 v3, s[8:11], s71 offen nt lds
    s_add_u32 m0, s35, 3072
    s_add_u32 s71, s70, 3072
    buffer_load_dwordx4 v3, s[8:11], s71 offen nt lds
    s_add_u32 m0, s35, 4096
    s_add_u32 s71, s70, 32768
    buffer_load_dwordx4 v3, s[8:11], s71 offen nt lds
    s_add_u32 m0, s35, 5120
    s_add_u32 s71, s70, 33792
    buffer_load_dwordx4 v3, s[8:11], s71 offen nt lds
    s_add_u32 m0, s35, 6144
    s_add_u32 s71, s70, 34816
    buffer_load_dwordx4 v3, s[8:11], s71 offen nt lds
    s_add_u32 m0, s35, 7168
    s_add_u32 s71, s70, 35840
    buffer_load_dwordx4 v3, s[8:11], s71 offen nt lds
    ds_read_b32 v17, v0 offset:8
    s_waitcnt lgkmcnt(0)
    v_readfirstlane_b32 s81, v17
    s_mov_b32 s79, 2
    s_cmp_lg_u32 s81, 0
    s_nop 1
    s_cbranch_scc1 L_qk_w2
    s_waitcnt vmcnt(3)
    s_add_u32 m0, s35, 8192
    s_add_u32 s71, s70, 65536
    buffer_load_dwordx4 v3, s[8:11], s71 offen nt lds
    s_waitcnt vmcnt(3)
    s_add_u32 m0, s35, 9216
    s_add_u32 s71, s70, 66560
    buffer_load_dwordx4 v3, s[8:11], s71 offen nt lds
    s_waitcnt vmcnt(3)
    s_add_u32 m0, s35, 10240
    s_add_u32 s71, s70, 67584
    buffer_load_dwordx4 v3, s[8:11], s71 offen nt lds
    s_waitcnt vmcnt(3)
    s_add_u32 m0, s35, 11264
    s_add_u32 s71, s70, 68608
    buffer_load_dwordx4 v3, s[8:11], s71 offen nt lds
    ds_read_b32 v17, v0 offset:8
    s_waitcnt lgkmcnt(0)
    v_readfirstlane_b32 s81, v17
    s_mov_b32 s79, 3
    s_cmp_lg_u32 s81, 0
    s_nop 1
    s_cbranch_scc1 L_qk_w3
    s_waitcnt vmcnt(3)
    s_add_u32 m0, s35, 12288
    s_add_u32 s71, s70, 98304
    buffer_load_dwordx4 v3, s[8:11], s71 offen nt lds
    s_waitcnt vmcnt(3)
    s_add_u32 m0, s35, 13312
    s_add_u32 s71, s70, 99328
    buffer_load_dwordx4 v3, s[8:11], s71 offen nt lds
    s_waitcnt vmcnt(3)
    s_add_u32 m0, s35, 14336
    s_add_u32 s71, s70, 100352
    buffer_load_dwordx4 v3, s[8:11], s71 offen nt lds
    s_waitcnt vmcnt(3)
    s_add_u32 m0, s35, 15360
    s_add_u32 s71, s70, 101376
    buffer_load_dwordx4 v3, s[8:11], s71 offen nt lds
    s_mov_b32 s80, 0
SP_110:
    ds_read_b32 v17, v0 offset:8
    s_waitcnt lgkmcnt(0)
    v_readfirstlane_b32 s81, v17
    s_cmp_ge_u32 s81, 1
    s_nop 2
    s_cbranch_scc1 SPD_111
    s_add_u32 s80, s80, 1
    s_cmp_gt_u32 s80, 100000
    s_cbranch_scc1 SPD_111
    s_sleep 1
    s_branch SP_110
SPD_111:
    s_mov_b32 s79, 4
    s_waitcnt vmcnt(16)
    s_branch L_qk
L_qk_w2:
    s_waitcnt vmcnt(8)
    s_branch L_qk
L_qk_w3:
    s_waitcnt vmcnt(12)
L_qk:
    s_setprio 1
    ds_read_b128 v[4:7], v18 offset:512
    s_waitcnt lgkmcnt(0)
    v_mov_b32 v0, v1
    v_mfma_f32_16x16x32_bf16 v[18:21], v[26:29], v[4:7], 0
    v_mfma_f32_16x16x32_bf16 v[22:25], v[30:33], v[4:7], 0
    s_nop 6
    v_mov_b32_dpp v8, v18 quad_perm:[0,0,0,0] row_mask:0xf bank_mask:0xf
    v_add_f32_dpp v8, v19, v8 quad_perm:[1,1,1,1] row_mask:0xf bank_mask:0xf
    v_add_f32_dpp v8, v20, v8 quad_perm:[2,2,2,2] row_mask:0xf bank_mask:0xf
    v_add_f32_dpp v8, v21, v8 quad_perm:[3,3,3,3] row_mask:0xf bank_mask:0xf
    v_mfma_f32_16x16x32_bf16 v[18:21], v[34:37], v[4:7], 0
    v_mov_b32_dpp v1, v22 quad_perm:[0,0,0,0] row_mask:0xf bank_mask:0xf
    v_add_f32_dpp v1, v23, v1 quad_perm:[1,1,1,1] row_mask:0xf bank_mask:0xf
    v_add_f32_dpp v1, v24, v1 quad_perm:[2,2,2,2] row_mask:0xf bank_mask:0xf
    v_add_f32_dpp v1, v25, v1 quad_perm:[3,3,3,3] row_mask:0xf bank_mask:0xf
    v_cndmask_b32 v8, v8, v1, s[60:61]
    v_mfma_f32_16x16x32_bf16 v[22:25], v[38:41], v[4:7], 0
    s_nop 1
    v_mov_b32_dpp v1, v18 quad_perm:[0,0,0,0] row_mask:0xf bank_mask:0xf
    v_add_f32_dpp v1, v19, v1 quad_perm:[1,1,1,1] row_mask:0xf bank_mask:0xf
    v_add_f32_dpp v1, v20, v1 quad_perm:[2,2,2,2] row_mask:0xf bank_mask:0xf
    v_add_f32_dpp v1, v21, v1 quad_perm:[3,3,3,3] row_mask:0xf bank_mask:0xf
    v_cndmask_b32 v8, v8, v1, s[62:63]
    v_mfma_f32_16x16x32_bf16 v[18:21], v[42:45], v[4:7], 0
    v_mov_b32_dpp v1, v22 quad_perm:[0,0,0,0] row_mask:0xf bank_mask:0xf
    v_add_f32_dpp v1, v23, v1 quad_perm:[1,1,1,1] row_mask:0xf bank_mask:0xf
    v_add_f32_dpp v1, v24, v1 quad_perm:[2,2,2,2] row_mask:0xf bank_mask:0xf
    v_add_f32_dpp v1, v25, v1 quad_perm:[3,3,3,3] row_mask:0xf bank_mask:0xf
    v_cndmask_b32 v8, v8, v1, s[64:65]
    v_mfma_f32_16x16x32_bf16 v[22:25], v[46:49], v[4:7], 0
    s_nop 1
    v_mov_b32_dpp v9, v18 quad_perm:[0,0,0,0] row_mask:0xf bank_mask:0xf
    v_add_f32_dpp v9, v19, v9 quad_perm:[1,1,1,1] row_mask:0xf bank_mask:0xf
    v_add_f32_dpp v9, v20, v9 quad_perm:[2,2,2,2] row_mask:0xf bank_mask:0xf
    v_add_f32_dpp v9, v21, v9 quad_perm:[3,3,3,3] row_mask:0xf bank_mask:0xf
    v_mfma_f32_16x16x32_bf16 v[18:21], v[50:53], v[4:7], 0
    s_nop 0
    v_mov_b32_dpp v1, v22 quad_perm:[0,0,0,0] row_mask:0xf bank_mask:0xf
    v_add_f32_dpp v1, v23, v1 quad_perm:[1,1,1,1] row_mask:0xf bank_mask:0xf
    v_add_f32_dpp v1, v24, v1 quad_perm:[2,2,2,2] row_mask:0xf bank_mask:0xf
    v_add_f32_dpp v1, v25, v1 quad_perm:[3,3,3,3] row_mask:0xf bank_mask:0xf
    v_cndmask_b32 v9, v9, v1, s[60:61]
    v_mfma_f32_16x16x32_bf16 v[22:25], v[54:57], v[4:7], 0
    s_nop 0
    v_mov_b32_dpp v1, v18 quad_perm:[0,0,0,0] row_mask:0xf bank_mask:0xf
    v_add_f32_dpp v1, v19, v1 quad_perm:[1,1,1,1] row_mask:0xf bank_mask:0xf
    v_add_f32_dpp v1, v20, v1 quad_perm:[2,2,2,2] row_mask:0xf bank_mask:0xf
    v_add_f32_dpp v1, v21, v1 quad_perm:[3,3,3,3] row_mask:0xf bank_mask:0xf
    v_cndmask_b32 v9, v9, v1, s[62:63]
    v_mfma_f32_16x16x32_bf16 v[18:21], v[58:61], v[4:7], 0
    s_nop 0
    v_mov_b32_dpp v1, v22 quad_perm:[0,0,0,0] row_mask:0xf bank_mask:0xf
    v_add_f32_dpp v1, v23, v1 quad_perm:[1,1,1,1] row_mask:0xf bank_mask:0xf
    v_add_f32_dpp v1, v24, v1 quad_perm:[2,2,2,2] row_mask:0xf bank_mask:0xf
    v_add_f32_dpp v1, v25, v1 quad_perm:[3,3,3,3] row_mask:0xf bank_mask:0xf
    v_cndmask_b32 v9, v9, v1, s[64:65]
    v_mfma_f32_16x16x32_bf16 v[22:25], v[62:65], v[4:7], 0
    s_nop 0
    v_mov_b32_dpp v10, v18 quad_perm:[0,0,0,0] row_mask:0xf bank_mask:0xf
    v_add_f32_dpp v10, v19, v10 quad_perm:[1,1,1,1] row_mask:0xf bank_mask:0xf
    v_add_f32_dpp v10, v20, v10 quad_perm:[2,2,2,2] row_mask:0xf bank_mask:0xf
    v_add_f32_dpp v10, v21, v10 quad_perm:[3,3,3,3] row_mask:0xf bank_mask:0xf
    v_mfma_f32_16x16x32_bf16 v[18:21], v[66:69], v[4:7], 0
    s_nop 1
    v_mov_b32_dpp v1, v22 quad_perm:[0,0,0,0] row_mask:0xf bank_mask:0xf
    v_add_f32_dpp v1, v23, v1 quad_perm:[1,1,1,1] row_mask:0xf bank_mask:0xf
    v_add_f32_dpp v1, v24, v1 quad_perm:[2,2,2,2] row_mask:0xf bank_mask:0xf
    v_add_f32_dpp v1, v25, v1 quad_perm:[3,3,3,3] row_mask:0xf bank_mask:0xf
    v_cndmask_b32 v10, v10, v1, s[60:61]
    v_mfma_f32_16x16x32_bf16 v[22:25], v[70:73], v[4:7], 0
    v_mov_b32_dpp v1, v18 quad_perm:[0,0,0,0] row_mask:0xf bank_mask:0xf
    v_add_f32_dpp v1, v19, v1 quad_perm:[1,1,1,1] row_mask:0xf bank_mask:0xf
    v_add_f32_dpp v1, v20, v1 quad_perm:[2,2,2,2] row_mask:0xf bank_mask:0xf
    v_add_f32_dpp v1, v21, v1 quad_perm:[3,3,3,3] row_mask:0xf bank_mask:0xf
    v_cndmask_b32 v10, v10, v1, s[62:63]
    v_mfma_f32_16x16x32_bf16 v[18:21], v[74:77], v[4:7], 0
    s_nop 1
    v_mov_b32_dpp v1, v22 quad_perm:[0,0,0,0] row_mask:0xf bank_mask:0xf
    v_add_f32_dpp v1, v23, v1 quad_perm:[1,1,1,1] row_mask:0xf bank_mask:0xf
    v_add_f32_dpp v1, v24, v1 quad_perm:[2,2,2,2] row_mask:0xf bank_mask:0xf
    v_add_f32_dpp v1, v25, v1 quad_perm:[3,3,3,3] row_mask:0xf bank_mask:0xf
    v_cndmask_b32 v10, v10, v1, s[64:65]
    v_mfma_f32_16x16x32_bf16 v[22:25], v[78:81], v[4:7], 0
    v_mov_b32_dpp v11, v18 quad_perm:[0,0,0,0] row_mask:0xf bank_mask:0xf
    v_add_f32_dpp v11, v19, v11 quad_perm:[1,1,1,1] row_mask:0xf bank_mask:0xf
    v_add_f32_dpp v11, v20, v11 quad_perm:[2,2,2,2] row_mask:0xf bank_mask:0xf
    v_add_f32_dpp v11, v21, v11 quad_perm:[3,3,3,3] row_mask:0xf bank_mask:0xf
    v_mfma_f32_16x16x32_bf16 v[18:21], v[82:85], v[4:7], 0
    s_nop 2
    v_mov_b32_dpp v1, v22 quad_perm:[0,0,0,0] row_mask:0xf bank_mask:0xf
    v_add_f32_dpp v1, v23, v1 quad_perm:[1,1,1,1] row_mask:0xf bank_mask:0xf
    v_add_f32_dpp v1, v24, v1 quad_perm:[2,2,2,2] row_mask:0xf bank_mask:0xf
    v_add_f32_dpp v1, v25, v1 quad_perm:[3,3,3,3] row_mask:0xf bank_mask:0xf
    v_cndmask_b32 v11, v11, v1, s[60:61]
    v_mfma_f32_16x16x32_bf16 v[22:25], v[86:89], v[4:7], 0
    v_mov_b32_dpp v1, v18 quad_perm:[0,0,0,0] row_mask:0xf bank_mask:0xf
    v_add_f32_dpp v1, v19, v1 quad_perm:[1,1,1,1] row_mask:0xf bank_mask:0xf
    v_add_f32_dpp v1, v20, v1 quad_perm:[2,2,2,2] row_mask:0xf bank_mask:0xf
    v_add_f32_dpp v1, v21, v1 quad_perm:[3,3,3,3] row_mask:0xf bank_mask:0xf
    v_cndmask_b32 v11, v11, v1, s[62:63]
    v_mfma_f32_16x16x32_bf16 v[18:21], v[90:93], v[4:7], 0
    s_nop 1
    v_mov_b32_dpp v1, v22 quad_perm:[0,0,0,0] row_mask:0xf bank_mask:0xf
    v_add_f32_dpp v1, v23, v1 quad_perm:[1,1,1,1] row_mask:0xf bank_mask:0xf
    v_add_f32_dpp v1, v24, v1 quad_perm:[2,2,2,2] row_mask:0xf bank_mask:0xf
    v_add_f32_dpp v1, v25, v1 quad_perm:[3,3,3,3] row_mask:0xf bank_mask:0xf
    v_cndmask_b32 v11, v11, v1, s[64:65]
    v_mfma_f32_16x16x32_bf16 v[22:25], v[94:97], v[4:7], 0
    v_mov_b32_dpp v12, v18 quad_perm:[0,0,0,0] row_mask:0xf bank_mask:0xf
    v_add_f32_dpp v12, v19, v12 quad_perm:[1,1,1,1] row_mask:0xf bank_mask:0xf
    v_add_f32_dpp v12, v20, v12 quad_perm:[2,2,2,2] row_mask:0xf bank_mask:0xf
    v_add_f32_dpp v12, v21, v12 quad_perm:[3,3,3,3] row_mask:0xf bank_mask:0xf
    v_mfma_f32_16x16x32_bf16 v[18:21], v[98:101], v[4:7], 0
    s_nop 2
    v_mov_b32_dpp v1, v22 quad_perm:[0,0,0,0] row_mask:0xf bank_mask:0xf
    v_add_f32_dpp v1, v23, v1 quad_perm:[1,1,1,1] row_mask:0xf bank_mask:0xf
    v_add_f32_dpp v1, v24, v1 quad_perm:[2,2,2,2] row_mask:0xf bank_mask:0xf
    v_add_f32_dpp v1, v25, v1 quad_perm:[3,3,3,3] row_mask:0xf bank_mask:0xf
    v_cndmask_b32 v12, v12, v1, s[60:61]
    v_mfma_f32_16x16x32_bf16 v[22:25], v[102:105], v[4:7], 0
    v_mov_b32_dpp v1, v18 quad_perm:[0,0,0,0] row_mask:0xf bank_mask:0xf
    v_add_f32_dpp v1, v19, v1 quad_perm:[1,1,1,1] row_mask:0xf bank_mask:0xf
    v_add_f32_dpp v1, v20, v1 quad_perm:[2,2,2,2] row_mask:0xf bank_mask:0xf
    v_add_f32_dpp v1, v21, v1 quad_perm:[3,3,3,3] row_mask:0xf bank_mask:0xf
    v_cndmask_b32 v12, v12, v1, s[62:63]
    v_mfma_f32_16x16x32_bf16 v[18:21], v[106:109], v[4:7], 0
    s_nop 1
    v_mov_b32_dpp v1, v22 quad_perm:[0,0,0,0] row_mask:0xf bank_mask:0xf
    v_add_f32_dpp v1, v23, v1 quad_perm:[1,1,1,1] row_mask:0xf bank_mask:0xf
    v_add_f32_dpp v1, v24, v1 quad_perm:[2,2,2,2] row_mask:0xf bank_mask:0xf
    v_add_f32_dpp v1, v25, v1 quad_perm:[3,3,3,3] row_mask:0xf bank_mask:0xf
    v_cndmask_b32 v12, v12, v1, s[64:65]
    v_mfma_f32_16x16x32_bf16 v[22:25], v[110:113], v[4:7], 0
    v_mov_b32_dpp v13, v18 quad_perm:[0,0,0,0] row_mask:0xf bank_mask:0xf
    v_add_f32_dpp v13, v19, v13 quad_perm:[1,1,1,1] row_mask:0xf bank_mask:0xf
    v_add_f32_dpp v13, v20, v13 quad_perm:[2,2,2,2] row_mask:0xf bank_mask:0xf
    v_add_f32_dpp v13, v21, v13 quad_perm:[3,3,3,3] row_mask:0xf bank_mask:0xf
    v_mfma_f32_16x16x32_bf16 v[18:21], v[114:117], v[4:7], 0
    s_nop 2
    v_mov_b32_dpp v1, v22 quad_perm:[0,0,0,0] row_mask:0xf bank_mask:0xf
    v_add_f32_dpp v1, v23, v1 quad_perm:[1,1,1,1] row_mask:0xf bank_mask:0xf
    v_add_f32_dpp v1, v24, v1 quad_perm:[2,2,2,2] row_mask:0xf bank_mask:0xf
    v_add_f32_dpp v1, v25, v1 quad_perm:[3,3,3,3] row_mask:0xf bank_mask:0xf
    v_cndmask_b32 v13, v13, v1, s[60:61]
    v_mfma_f32_16x16x32_bf16 v[22:25], v[118:121], v[4:7], 0
    v_mov_b32_dpp v1, v18 quad_perm:[0,0,0,0] row_mask:0xf bank_mask:0xf
    v_add_f32_dpp v1, v19, v1 quad_perm:[1,1,1,1] row_mask:0xf bank_mask:0xf
    v_add_f32_dpp v1, v20, v1 quad_perm:[2,2,2,2] row_mask:0xf bank_mask:0xf
    v_add_f32_dpp v1, v21, v1 quad_perm:[3,3,3,3] row_mask:0xf bank_mask:0xf
    v_cndmask_b32 v13, v13, v1, s[62:63]
    v_mfma_f32_16x16x32_bf16 v[18:21], v[122:125], v[4:7], 0
    s_nop 1
    v_mov_b32_dpp v1, v22 quad_perm:[0,0,0,0] row_mask:0xf bank_mask:0xf
    v_add_f32_dpp v1, v23, v1 quad_perm:[1,1,1,1] row_mask:0xf bank_mask:0xf
    v_add_f32_dpp v1, v24, v1 quad_perm:[2,2,2,2] row_mask:0xf bank_mask:0xf
    v_add_f32_dpp v1, v25, v1 quad_perm:[3,3,3,3] row_mask:0xf bank_mask:0xf
    v_cndmask_b32 v13, v13, v1, s[64:65]
    v_mfma_f32_16x16x32_bf16 v[22:25], v[126:129], v[4:7], 0
    v_mov_b32_dpp v1, v18 quad_perm:[0,0,0,0] row_mask:0xf bank_mask:0xf
    v_add_f32_dpp v1, v19, v1 quad_perm:[1,1,1,1] row_mask:0xf bank_mask:0xf
    v_add_f32_dpp v1, v20, v1 quad_perm:[2,2,2,2] row_mask:0xf bank_mask:0xf
    v_add_f32_dpp v1, v21, v1 quad_perm:[3,3,3,3] row_mask:0xf bank_mask:0xf
    v_cndmask_b32 v14, v14, v1, s[58:59]
    v_mfma_f32_16x16x32_bf16 v[18:21], v[130:133], v[4:7], 0
    s_nop 1
    v_mov_b32_dpp v1, v22 quad_perm:[0,0,0,0] row_mask:0xf bank_mask:0xf
    v_add_f32_dpp v1, v23, v1 quad_perm:[1,1,1,1] row_mask:0xf bank_mask:0xf
    v_add_f32_dpp v1, v24, v1 quad_perm:[2,2,2,2] row_mask:0xf bank_mask:0xf
    v_add_f32_dpp v1, v25, v1 quad_perm:[3,3,3,3] row_mask:0xf bank_mask:0xf
    v_cndmask_b32 v14, v14, v1, s[60:61]
    v_mfma_f32_16x16x32_bf16 v[22:25], v[134:137], v[4:7], 0
    v_mov_b32_dpp v1, v18 quad_perm:[0,0,0,0] row_mask:0xf bank_mask:0xf
    v_add_f32_dpp v1, v19, v1 quad_perm:[1,1,1,1] row_mask:0xf bank_mask:0xf
    v_add_f32_dpp v1, v20, v1 quad_perm:[2,2,2,2] row_mask:0xf bank_mask:0xf
    v_add_f32_dpp v1, v21, v1 quad_perm:[3,3,3,3] row_mask:0xf bank_mask:0xf
    v_cndmask_b32 v14, v14, v1, s[40:41]
    v_mfma_f32_16x16x32_bf16 v[18:21], v[138:141], v[4:7], 0
    s_nop 1
    v_mov_b32_dpp v1, v22 quad_perm:[0,0,0,0] row_mask:0xf bank_mask:0xf
    v_add_f32_dpp v1, v23, v1 quad_perm:[1,1,1,1] row_mask:0xf bank_mask:0xf
    v_add_f32_dpp v1, v24, v1 quad_perm:[2,2,2,2] row_mask:0xf bank_mask:0xf
    v_add_f32_dpp v1, v25, v1 quad_perm:[3,3,3,3] row_mask:0xf bank_mask:0xf
    v_cndmask_b32 v14, v14, v1, s[42:43]
    v_mfma_f32_16x16x32_bf16 v[22:25], v[142:145], v[4:7], 0
    v_mov_b32_dpp v1, v18 quad_perm:[0,0,0,0] row_mask:0xf bank_mask:0xf
    v_add_f32_dpp v1, v19, v1 quad_perm:[1,1,1,1] row_mask:0xf bank_mask:0xf
    v_add_f32_dpp v1, v20, v1 quad_perm:[2,2,2,2] row_mask:0xf bank_mask:0xf
    v_add_f32_dpp v1, v21, v1 quad_perm:[3,3,3,3] row_mask:0xf bank_mask:0xf
    v_cndmask_b32 v15, v15, v1, s[44:45]
    v_mfma_f32_16x16x32_bf16 v[18:21], v[146:149], v[4:7], 0
    s_nop 1
    v_mov_b32_dpp v1, v22 quad_perm:[0,0,0,0] row_mask:0xf bank_mask:0xf
    v_add_f32_dpp v1, v23, v1 quad_perm:[1,1,1,1] row_mask:0xf bank_mask:0xf
    v_add_f32_dpp v1, v24, v1 quad_perm:[2,2,2,2] row_mask:0xf bank_mask:0xf
    v_add_f32_dpp v1, v25, v1 quad_perm:[3,3,3,3] row_mask:0xf bank_mask:0xf
    v_cndmask_b32 v15, v15, v1, s[46:47]
    v_mfma_f32_16x16x32_bf16 v[22:25], v[150:153], v[4:7], 0
    v_mov_b32_dpp v1, v18 quad_perm:[0,0,0,0] row_mask:0xf bank_mask:0xf
    v_add_f32_dpp v1, v19, v1 quad_perm:[1,1,1,1] row_mask:0xf bank_mask:0xf
    v_add_f32_dpp v1, v20, v1 quad_perm:[2,2,2,2] row_mask:0xf bank_mask:0xf
    v_add_f32_dpp v1, v21, v1 quad_perm:[3,3,3,3] row_mask:0xf bank_mask:0xf
    v_cndmask_b32 v15, v15, v1, s[48:49]
    v_mfma_f32_16x16x32_bf16 v[18:21], v[154:157], v[4:7], 0
    s_nop 1
    v_mov_b32_dpp v1, v22 quad_perm:[0,0,0,0] row_mask:0xf bank_mask:0xf
    v_add_f32_dpp v1, v23, v1 quad_perm:[1,1,1,1] row_mask:0xf bank_mask:0xf
    v_add_f32_dpp v1, v24, v1 quad_perm:[2,2,2,2] row_mask:0xf bank_mask:0xf
    v_add_f32_dpp v1, v25, v1 quad_perm:[3,3,3,3] row_mask:0xf bank_mask:0xf
    v_cndmask_b32 v15, v15, v1, s[50:51]
    v_mfma_f32_16x16x32_bf16 v[22:25], v[158:161], v[4:7], 0
    v_mov_b32_dpp v1, v18 quad_perm:[0,0,0,0] row_mask:0xf bank_mask:0xf
    v_add_f32_dpp v1, v19, v1 quad_perm:[1,1,1,1] row_mask:0xf bank_mask:0xf
    v_add_f32_dpp v1, v20, v1 quad_perm:[2,2,2,2] row_mask:0xf bank_mask:0xf
    v_add_f32_dpp v1, v21, v1 quad_perm:[3,3,3,3] row_mask:0xf bank_mask:0xf
    v_cndmask_b32 v16, v16, v1, s[52:53]
    v_mfma_f32_16x16x32_bf16 v[18:21], v[162:165], v[4:7], 0
    s_nop 1
    v_mov_b32_dpp v1, v22 quad_perm:[0,0,0,0] row_mask:0xf bank_mask:0xf
    v_add_f32_dpp v1, v23, v1 quad_perm:[1,1,1,1] row_mask:0xf bank_mask:0xf
    v_add_f32_dpp v1, v24, v1 quad_perm:[2,2,2,2] row_mask:0xf bank_mask:0xf
    v_add_f32_dpp v1, v25, v1 quad_perm:[3,3,3,3] row_mask:0xf bank_mask:0xf
    v_cndmask_b32 v16, v16, v1, s[54:55]
    s_nop 0
    v_mov_b32_dpp v1, v18 quad_perm:[0,0,0,0] row_mask:0xf bank_mask:0xf
    v_add_f32_dpp v1, v19, v1 quad_perm:[1,1,1,1] row_mask:0xf bank_mask:0xf
    v_add_f32_dpp v1, v20, v1 quad_perm:[2,2,2,2] row_mask:0xf bank_mask:0xf
    v_add_f32_dpp v1, v21, v1 quad_perm:[3,3,3,3] row_mask:0xf bank_mask:0xf
    v_cndmask_b32 v16, v16, v1, s[56:57]
    v_cvt_pk_bf16_f32 v18, v8, v9
    v_cvt_pk_bf16_f32 v19, v10, v11
    v_cvt_pk_bf16_f32 v20, v12, v13
    v_cvt_pk_bf16_f32 v21, v14, v15
    v_cvt_pk_bf16_f32 v22, v16, v16
    v_lshlrev_b32 v8, 16, v18
    v_and_b32 v9, 0xffff0000, v18
    v_lshlrev_b32 v10, 16, v19
    v_and_b32 v11, 0xffff0000, v19
    v_lshlrev_b32 v12, 16, v20
    v_and_b32 v13, 0xffff0000, v20
    v_lshlrev_b32 v14, 16, v21
    v_and_b32 v15, 0xffff0000, v21
    v_lshlrev_b32 v16, 16, v22
    s_mov_b32 s82, 0x3db504f3
    v_mul_f32 v8, s82, v8
    v_mul_f32 v9, s82, v9
    v_mul_f32 v10, s82, v10
    v_mul_f32 v11, s82, v11
    v_mul_f32 v12, s82, v12
    v_mul_f32 v13, s82, v13
    v_mul_f32 v14, s82, v14
    v_mul_f32 v15, s82, v15
    v_mul_f32 v16, s82, v16
    v_cvt_pk_bf16_f32 v18, v8, v9
    v_cvt_pk_bf16_f32 v19, v10, v11
    v_cvt_pk_bf16_f32 v20, v12, v13
    v_cvt_pk_bf16_f32 v21, v14, v15
    v_cvt_pk_bf16_f32 v22, v16, v16
    v_lshlrev_b32 v8, 16, v18
    v_and_b32 v9, 0xffff0000, v18
    v_lshlrev_b32 v10, 16, v19
    v_and_b32 v11, 0xffff0000, v19
    v_lshlrev_b32 v12, 16, v20
    v_and_b32 v13, 0xffff0000, v20
    v_lshlrev_b32 v14, 16, v21
    v_and_b32 v15, 0xffff0000, v21
    v_lshlrev_b32 v16, 16, v22
    v_max3_f32 v18, v8, v9, v10
    v_max3_f32 v19, v11, v12, v13
    v_max3_f32 v20, v14, v15, v16
    v_max3_f32 v18, v18, v19, v20
    s_nop 1
    v_max_f32_dpp v18, v18, v18 quad_perm:[1,0,3,2] row_mask:0xf bank_mask:0xf
    s_nop 1
    v_max_f32_dpp v18, v18, v18 quad_perm:[2,3,0,1] row_mask:0xf bank_mask:0xf
    v_mov_b32 v19, v18
    s_nop 1
    v_permlane16_swap_b32 v18, v19
    v_max_f32 v18, v18, v19
    v_mov_b32 v19, v18
    s_nop 1
    v_permlane32_swap_b32 v18, v19
    v_max_f32 v18, v18, v19
    s_mov_b32 s83, 0x3fb8aa3b
    v_lshlrev_b32 v24, 3, v0
    s_lshl_b32 s81, s3, 2
    v_add_u32 v24, s81, v24
    v_mov_b32 v1, 0
    s_mov_b64 exec, 0x11
    ds_write_b32 v24, v18 offset:128
    s_mov_b64 exec, -1
    s_waitcnt lgkmcnt(0)
    v_mov_b32 v17, 1
    s_mov_b64 exec, 1
    ds_add_u32 v1, v17 offset:0
    s_mov_b64 exec, -1
    v_and_b32 v18, 3, v0
    v_bfe_u32 v19, v0, 3, 1
    v_lshl_add_u32 v18, v19, 2, v18
    v_and_b32 v19, 1, v18
    v_lshlrev_b32 v19, 4, v19
    v_mov_b32 v17, 0xffff
    v_lshlrev_b32 v19, v19, v17
    v_lshrrev_b32 v18, 1, v18
    v_cmp_eq_u32 vcc, 0, v18
    s_nop 1
    v_cndmask_b32 v150, 0, v19, vcc
    v_cmp_eq_u32 vcc, 1, v18
    s_nop 1
    v_cndmask_b32 v151, 0, v19, vcc
    v_cmp_eq_u32 vcc, 2, v18
    s_nop 1
    v_cndmask_b32 v152, 0, v19, vcc
    v_cmp_eq_u32 vcc, 3, v18
    s_nop 1
    v_cndmask_b32 v153, 0, v19, vcc
    v_bfe_u32 v18, v0, 2, 1
    v_lshlrev_b32 v18, 5, v18
    v_and_b32 v20, 15, v0
    v_lshlrev_b32 v20, 5, v20
    v_bfe_u32 v19, v0, 4, 1
    v_lshl_add_u32 v20, v19, 9, v20
    v_lshrrev_b32 v19, 5, v0
    v_lshl_add_u32 v20, v19, 4, v20
    s_lshl_b32 s81, s3, 10
    v_add_u32 v20, s81, v20
    v_add_u32 v21, s35, v3
    s_setprio 1
    s_cmp_lt_u32 s3, 4
    s_cbranch_scc1 YP_112
    s_setprio 2
YP_112:
    s_cmp_gt_u32 s79, 2
    s_cbranch_scc1 L_dma2
    s_waitcnt vmcnt(7)
    s_add_u32 m0, s35, 8192
    s_add_u32 s71, s70, 65536
    buffer_load_dwordx4 v3, s[8:11], s71 offen nt lds
    s_waitcnt vmcnt(7)
    s_add_u32 m0, s35, 9216
    s_add_u32 s71, s70, 66560
    buffer_load_dwordx4 v3, s[8:11], s71 offen nt lds
    s_waitcnt vmcnt(7)
    s_add_u32 m0, s35, 10240
    s_add_u32 s71, s70, 67584
    buffer_load_dwordx4 v3, s[8:11], s71 offen nt lds
    s_waitcnt vmcnt(7)
    s_add_u32 m0, s35, 11264
    s_add_u32 s71, s70, 68608
    buffer_load_dwordx4 v3, s[8:11], s71 offen nt lds
L_dma2:
    s_cmp_gt_u32 s79, 3
    s_cbranch_scc1 L_dma3
    s_waitcnt vmcnt(7)
    s_add_u32 m0, s35, 12288
    s_add_u32 s71, s70, 98304
    buffer_load_dwordx4 v3, s[8:11], s71 offen nt lds
    s_waitcnt vmcnt(7)
    s_add_u32 m0, s35, 13312
    s_add_u32 s71, s70, 99328
    buffer_load_dwordx4 v3, s[8:11], s71 offen nt lds
    s_waitcnt vmcnt(7)
    s_add_u32 m0, s35, 14336
    s_add_u32 s71, s70, 100352
    buffer_load_dwordx4 v3, s[8:11], s71 offen nt lds
    s_waitcnt vmcnt(7)
    s_add_u32 m0, s35, 15360
    s_add_u32 s71, s70, 101376
    buffer_load_dwordx4 v3, s[8:11], s71 offen nt lds
L_dma3:
    s_waitcnt vmcnt(7)
    buffer_load_dwordx4 v[66:69], v3, s[8:11], s18 offen nt
    s_waitcnt vmcnt(7)
    buffer_load_dwordx4 v[70:73], v3, s[8:11], s19 offen nt
    s_waitcnt vmcnt(7)
    buffer_load_dwordx4 v[74:77], v3, s[8:11], s20 offen nt
    s_waitcnt vmcnt(7)
    buffer_load_dwordx4 v[78:81], v3, s[8:11], s21 offen nt
    s_waitcnt vmcnt(7)
    buffer_load_dwordx4 v[82:85], v3, s[8:11], s22 offen nt
    s_waitcnt vmcnt(7)
    buffer_load_dwordx4 v[86:89], v3, s[8:11], s23 offen nt
    s_waitcnt vmcnt(7)
    buffer_load_dwordx4 v[90:93], v3, s[8:11], s24 offen nt
    s_waitcnt vmcnt(7)
    buffer_load_dwordx4 v[94:97], v3, s[8:11], s25 offen nt
    s_mov_b32 s80, 0
SP_113:
    ds_read_b32 v17, v1 offset:0
    s_waitcnt lgkmcnt(0)
    v_readfirstlane_b32 s81, v17
    s_cmp_ge_u32 s81, 9
    s_nop 2
    s_cbranch_scc1 SPD_114
    s_add_u32 s80, s80, 1
    s_cmp_gt_u32 s80, 100000
    s_cbranch_scc1 SPD_114
    s_sleep 1
    s_branch SP_113
SPD_114:
    ds_read_b128 v[154:157], v18 offset:128
    ds_read_b128 v[158:161], v18 offset:144
    s_waitcnt lgkmcnt(0)
    v_max3_f32 v18, v154, v155, v156
    v_max3_f32 v19, v157, v158, v159
    v_max3_f32 v18, v18, v160, v161
    v_max_f32 v18, v18, v19
    v_sub_f32 v8, v8, v18
    v_sub_f32 v9, v9, v18
    v_sub_f32 v10, v10, v18
    v_sub_f32 v11, v11, v18
    v_sub_f32 v12, v12, v18
    v_sub_f32 v13, v13, v18
    v_sub_f32 v14, v14, v18
    v_sub_f32 v15, v15, v18
    v_sub_f32 v16, v16, v18
    v_mul_f32 v8, s83, v8
    v_mul_f32 v9, s83, v9
    v_mul_f32 v10, s83, v10
    v_mul_f32 v11, s83, v11
    v_mul_f32 v12, s83, v12
    v_mul_f32 v13, s83, v13
    v_mul_f32 v14, s83, v14
    v_mul_f32 v15, s83, v15
    v_mul_f32 v16, s83, v16
    v_exp_f32 v8, v8
    v_exp_f32 v9, v9
    v_exp_f32 v10, v10
    v_exp_f32 v11, v11
    v_exp_f32 v12, v12
    v_exp_f32 v13, v13
    v_exp_f32 v14, v14
    v_exp_f32 v15, v15
    v_exp_f32 v16, v16
    v_pk_add_f32 v[18:19], v[8:9], v[10:11]
    v_pk_add_f32 v[22:23], v[12:13], v[14:15]
    v_pk_add_f32 v[18:19], v[18:19], v[22:23]
    v_add_f32 v19, v18, v19
    v_add_f32 v19, v19, v16
    v_cvt_pk_bf16_f32 v8, v8, v8
    v_cvt_pk_bf16_f32 v9, v9, v9
    v_cvt_pk_bf16_f32 v10, v10, v10
    v_cvt_pk_bf16_f32 v11, v11, v11
    v_cvt_pk_bf16_f32 v12, v12, v12
    v_cvt_pk_bf16_f32 v13, v13, v13
    v_cvt_pk_bf16_f32 v14, v14, v14
    v_cvt_pk_bf16_f32 v15, v15, v15
    v_cvt_pk_bf16_f32 v16, v16, v16
    v_add_f32_dpp v19, v19, v19 quad_perm:[1,0,3,2] row_mask:0xf bank_mask:0xf
    s_nop 1
    v_add_f32_dpp v19, v19, v19 quad_perm:[2,3,0,1] row_mask:0xf bank_mask:0xf
    v_mov_b32 v18, v19
    s_nop 1
    v_permlane16_swap_b32 v19, v18
    v_add_f32 v19, v19, v18
    v_mov_b32 v18, v19
    s_nop 1
    v_permlane32_swap_b32 v19, v18
    v_add_f32 v19, v19, v18
    s_mov_b64 exec, 0x11
    ds_write_b32 v24, v19 offset:192
    s_mov_b64 exec, -1
    s_waitcnt lgkmcnt(0)
    v_mov_b32 v17, 1
    s_mov_b64 exec, 1
    ds_add_u32 v1, v17 offset:48
    s_mov_b64 exec, -1
    s_waitcnt vmcnt(7)
    buffer_load_dwordx4 v[98:101], v3, s[8:11], s26 offen nt
    s_setprio 1
    s_waitcnt vmcnt(7)
    s_add_u32 s71, s70, 131072
    buffer_load_dwordx4 v[26:29], v3, s[8:11], s71 offen nt
    s_waitcnt vmcnt(7)
    s_add_u32 s71, s70, 132096
    buffer_load_dwordx4 v[30:33], v3, s[8:11], s71 offen nt
    s_waitcnt vmcnt(7)
    s_add_u32 s71, s70, 133120
    buffer_load_dwordx4 v[34:37], v3, s[8:11], s71 offen nt
    s_waitcnt vmcnt(7)
    s_add_u32 s71, s70, 134144
    buffer_load_dwordx4 v[38:41], v3, s[8:11], s71 offen nt
    s_waitcnt vmcnt(7)
    s_add_u32 s71, s70, 163840
    buffer_load_dwordx4 v[42:45], v3, s[8:11], s71 offen nt
    s_setprio 0
    s_cmp_lt_u32 s3, 4
    s_cbranch_scc1 YP_115
    s_setprio 1
YP_115:
    s_waitcnt vmcnt(7)
    s_add_u32 s71, s70, 164864
    buffer_load_dwordx4 v[46:49], v3, s[8:11], s71 offen nt
    s_waitcnt vmcnt(7)
    s_add_u32 s71, s70, 165888
    buffer_load_dwordx4 v[50:53], v3, s[8:11], s71 offen nt
    s_waitcnt vmcnt(7)
    s_add_u32 s71, s70, 166912
    buffer_load_dwordx4 v[54:57], v3, s[8:11], s71 offen nt
    s_waitcnt vmcnt(7)
    buffer_load_dwordx4 v[58:61], v3, s[8:11], s16 offen nt
    s_waitcnt vmcnt(7)
    buffer_load_dwordx4 v[62:65], v3, s[8:11], s17 offen nt
    s_waitcnt lgkmcnt(0)
    v_mov_b32 v17, 1
    s_mov_b64 exec, 1
    ds_add_u32 v1, v17 offset:28
    s_mov_b64 exec, -1
    s_waitcnt vmcnt(19)
    ds_read_b128 v[102:105], v21 offset:0
    ds_read_b128 v[106:109], v21 offset:1024
    ds_read_b128 v[110:113], v21 offset:2048
    ds_read_b128 v[114:117], v21 offset:3072
    ds_read_b128 v[118:121], v21 offset:4096
    ds_read_b128 v[122:125], v21 offset:5120
    ds_read_b128 v[126:129], v21 offset:6144
    ds_read_b128 v[130:133], v21 offset:7168
    ds_read_b128 v[134:137], v21 offset:8192
    ds_read_b128 v[138:141], v21 offset:9216
    ds_read_b128 v[142:145], v21 offset:10240
    ds_read_b128 v[146:149], v21 offset:11264
    v_and_b32_dpp v154, v8, v150 quad_perm:[0,0,0,0] row_mask:0xf bank_mask:0xf
    v_and_b32_dpp v155, v8, v151 quad_perm:[0,0,0,0] row_mask:0xf bank_mask:0xf
    v_and_b32_dpp v156, v8, v152 quad_perm:[0,0,0,0] row_mask:0xf bank_mask:0xf
    v_and_b32_dpp v157, v8, v153 quad_perm:[0,0,0,0] row_mask:0xf bank_mask:0xf
    v_and_b32_dpp v158, v8, v150 quad_perm:[1,1,1,1] row_mask:0xf bank_mask:0xf
    v_and_b32_dpp v159, v8, v151 quad_perm:[1,1,1,1] row_mask:0xf bank_mask:0xf
    v_and_b32_dpp v160, v8, v152 quad_perm:[1,1,1,1] row_mask:0xf bank_mask:0xf
    v_and_b32_dpp v161, v8, v153 quad_perm:[1,1,1,1] row_mask:0xf bank_mask:0xf
    s_waitcnt lgkmcnt(11)
    v_mfma_f32_16x16x32_bf16 v[162:165], v[154:157], v[102:105], 0
    ds_read_b128 v[102:105], v21 offset:12288
    v_and_b32_dpp v154, v8, v150 quad_perm:[2,2,2,2] row_mask:0xf bank_mask:0xf
    v_and_b32_dpp v155, v8, v151 quad_perm:[2,2,2,2] row_mask:0xf bank_mask:0xf
    v_and_b32_dpp v156, v8, v152 quad_perm:[2,2,2,2] row_mask:0xf bank_mask:0xf
    v_and_b32_dpp v157, v8, v153 quad_perm:[2,2,2,2] row_mask:0xf bank_mask:0xf
    s_waitcnt lgkmcnt(11)
    v_mfma_f32_16x16x32_bf16 v[162:165], v[158:161], v[106:109], v[162:165]
    ds_read_b128 v[106:109], v21 offset:13312
    v_and_b32_dpp v158, v8, v150 quad_perm:[3,3,3,3] row_mask:0xf bank_mask:0xf
    v_and_b32_dpp v159, v8, v151 quad_perm:[3,3,3,3] row_mask:0xf bank_mask:0xf
    v_and_b32_dpp v160, v8, v152 quad_perm:[3,3,3,3] row_mask:0xf bank_mask:0xf
    v_and_b32_dpp v161, v8, v153 quad_perm:[3,3,3,3] row_mask:0xf bank_mask:0xf
    s_waitcnt lgkmcnt(11)
    v_mfma_f32_16x16x32_bf16 v[162:165], v[154:157], v[110:113], v[162:165]
    ds_read_b128 v[110:113], v21 offset:14336
    v_and_b32_dpp v154, v9, v150 quad_perm:[0,0,0,0] row_mask:0xf bank_mask:0xf
    v_and_b32_dpp v155, v9, v151 quad_perm:[0,0,0,0] row_mask:0xf bank_mask:0xf
    v_and_b32_dpp v156, v9, v152 quad_perm:[0,0,0,0] row_mask:0xf bank_mask:0xf
    v_and_b32_dpp v157, v9, v153 quad_perm:[0,0,0,0] row_mask:0xf bank_mask:0xf
    s_waitcnt lgkmcnt(11)
    v_mfma_f32_16x16x32_bf16 v[162:165], v[158:161], v[114:117], v[162:165]
    ds_read_b128 v[114:117], v21 offset:15360
    v_and_b32_dpp v158, v9, v150 quad_perm:[1,1,1,1] row_mask:0xf bank_mask:0xf
    v_and_b32_dpp v159, v9, v151 quad_perm:[1,1,1,1] row_mask:0xf bank_mask:0xf
    v_and_b32_dpp v160, v9, v152 quad_perm:[1,1,1,1] row_mask:0xf bank_mask:0xf
    v_and_b32_dpp v161, v9, v153 quad_perm:[1,1,1,1] row_mask:0xf bank_mask:0xf
    s_waitcnt lgkmcnt(11)
    v_mfma_f32_16x16x32_bf16 v[162:165], v[154:157], v[118:121], v[162:165]
    v_and_b32_dpp v154, v9, v150 quad_perm:[2,2,2,2] row_mask:0xf bank_mask:0xf
    v_and_b32_dpp v155, v9, v151 quad_perm:[2,2,2,2] row_mask:0xf bank_mask:0xf
    v_and_b32_dpp v156, v9, v152 quad_perm:[2,2,2,2] row_mask:0xf bank_mask:0xf
    v_and_b32_dpp v157, v9, v153 quad_perm:[2,2,2,2] row_mask:0xf bank_mask:0xf
    s_waitcnt lgkmcnt(10)
    v_mfma_f32_16x16x32_bf16 v[162:165], v[158:161], v[122:125], v[162:165]
    v_and_b32_dpp v158, v9, v150 quad_perm:[3,3,3,3] row_mask:0xf bank_mask:0xf
    v_and_b32_dpp v159, v9, v151 quad_perm:[3,3,3,3] row_mask:0xf bank_mask:0xf
    v_and_b32_dpp v160, v9, v152 quad_perm:[3,3,3,3] row_mask:0xf bank_mask:0xf
    v_and_b32_dpp v161, v9, v153 quad_perm:[3,3,3,3] row_mask:0xf bank_mask:0xf
    s_waitcnt lgkmcnt(9)
    v_mfma_f32_16x16x32_bf16 v[162:165], v[154:157], v[126:129], v[162:165]
    v_and_b32_dpp v154, v10, v150 quad_perm:[0,0,0,0] row_mask:0xf bank_mask:0xf
    v_and_b32_dpp v155, v10, v151 quad_perm:[0,0,0,0] row_mask:0xf bank_mask:0xf
    v_and_b32_dpp v156, v10, v152 quad_perm:[0,0,0,0] row_mask:0xf bank_mask:0xf
    v_and_b32_dpp v157, v10, v153 quad_perm:[0,0,0,0] row_mask:0xf bank_mask:0xf
    s_waitcnt lgkmcnt(8)
    v_mfma_f32_16x16x32_bf16 v[162:165], v[158:161], v[130:133], v[162:165]
    v_and_b32_dpp v158, v10, v150 quad_perm:[1,1,1,1] row_mask:0xf bank_mask:0xf
    v_and_b32_dpp v159, v10, v151 quad_perm:[1,1,1,1] row_mask:0xf bank_mask:0xf
    v_and_b32_dpp v160, v10, v152 quad_perm:[1,1,1,1] row_mask:0xf bank_mask:0xf
    v_and_b32_dpp v161, v10, v153 quad_perm:[1,1,1,1] row_mask:0xf bank_mask:0xf
    s_waitcnt lgkmcnt(7)
    v_mfma_f32_16x16x32_bf16 v[162:165], v[154:157], v[134:137], v[162:165]
    v_and_b32_dpp v154, v10, v150 quad_perm:[2,2,2,2] row_mask:0xf bank_mask:0xf
    v_and_b32_dpp v155, v10, v151 quad_perm:[2,2,2,2] row_mask:0xf bank_mask:0xf
    v_and_b32_dpp v156, v10, v152 quad_perm:[2,2,2,2] row_mask:0xf bank_mask:0xf
    v_and_b32_dpp v157, v10, v153 quad_perm:[2,2,2,2] row_mask:0xf bank_mask:0xf
    s_waitcnt lgkmcnt(6)
    v_mfma_f32_16x16x32_bf16 v[162:165], v[158:161], v[138:141], v[162:165]
    v_and_b32_dpp v158, v10, v150 quad_perm:[3,3,3,3] row_mask:0xf bank_mask:0xf
    v_and_b32_dpp v159, v10, v151 quad_perm:[3,3,3,3] row_mask:0xf bank_mask:0xf
    v_and_b32_dpp v160, v10, v152 quad_perm:[3,3,3,3] row_mask:0xf bank_mask:0xf
    v_and_b32_dpp v161, v10, v153 quad_perm:[3,3,3,3] row_mask:0xf bank_mask:0xf
    s_waitcnt lgkmcnt(5)
    v_mfma_f32_16x16x32_bf16 v[162:165], v[154:157], v[142:145], v[162:165]
    v_and_b32_dpp v154, v11, v150 quad_perm:[0,0,0,0] row_mask:0xf bank_mask:0xf
    v_and_b32_dpp v155, v11, v151 quad_perm:[0,0,0,0] row_mask:0xf bank_mask:0xf
    v_and_b32_dpp v156, v11, v152 quad_perm:[0,0,0,0] row_mask:0xf bank_mask:0xf
    v_and_b32_dpp v157, v11, v153 quad_perm:[0,0,0,0] row_mask:0xf bank_mask:0xf
    s_waitcnt lgkmcnt(4)
    v_mfma_f32_16x16x32_bf16 v[162:165], v[158:161], v[146:149], v[162:165]
    v_and_b32_dpp v158, v11, v150 quad_perm:[1,1,1,1] row_mask:0xf bank_mask:0xf
    v_and_b32_dpp v159, v11, v151 quad_perm:[1,1,1,1] row_mask:0xf bank_mask:0xf
    v_and_b32_dpp v160, v11, v152 quad_perm:[1,1,1,1] row_mask:0xf bank_mask:0xf
    v_and_b32_dpp v161, v11, v153 quad_perm:[1,1,1,1] row_mask:0xf bank_mask:0xf
    s_waitcnt lgkmcnt(3)
    v_mfma_f32_16x16x32_bf16 v[162:165], v[154:157], v[102:105], v[162:165]
    v_and_b32_dpp v154, v11, v150 quad_perm:[2,2,2,2] row_mask:0xf bank_mask:0xf
    v_and_b32_dpp v155, v11, v151 quad_perm:[2,2,2,2] row_mask:0xf bank_mask:0xf
    v_and_b32_dpp v156, v11, v152 quad_perm:[2,2,2,2] row_mask:0xf bank_mask:0xf
    v_and_b32_dpp v157, v11, v153 quad_perm:[2,2,2,2] row_mask:0xf bank_mask:0xf
    s_waitcnt lgkmcnt(2)
    v_mfma_f32_16x16x32_bf16 v[162:165], v[158:161], v[106:109], v[162:165]
    v_and_b32_dpp v158, v11, v150 quad_perm:[3,3,3,3] row_mask:0xf bank_mask:0xf
    v_and_b32_dpp v159, v11, v151 quad_perm:[3,3,3,3] row_mask:0xf bank_mask:0xf
    v_and_b32_dpp v160, v11, v152 quad_perm:[3,3,3,3] row_mask:0xf bank_mask:0xf
    v_and_b32_dpp v161, v11, v153 quad_perm:[3,3,3,3] row_mask:0xf bank_mask:0xf
    s_waitcnt lgkmcnt(1)
    v_mfma_f32_16x16x32_bf16 v[162:165], v[154:157], v[110:113], v[162:165]
    v_and_b32_dpp v154, v14, v150 quad_perm:[2,2,2,2] row_mask:0xf bank_mask:0xf
    v_and_b32_dpp v155, v14, v151 quad_perm:[2,2,2,2] row_mask:0xf bank_mask:0xf
    v_and_b32_dpp v156, v14, v152 quad_perm:[2,2,2,2] row_mask:0xf bank_mask:0xf
    v_and_b32_dpp v157, v14, v153 quad_perm:[2,2,2,2] row_mask:0xf bank_mask:0xf
    s_waitcnt lgkmcnt(0)
    v_mfma_f32_16x16x32_bf16 v[162:165], v[158:161], v[114:117], v[162:165]
    v_and_b32_dpp v158, v14, v150 quad_perm:[3,3,3,3] row_mask:0xf bank_mask:0xf
    v_and_b32_dpp v159, v14, v151 quad_perm:[3,3,3,3] row_mask:0xf bank_mask:0xf
    v_and_b32_dpp v160, v14, v152 quad_perm:[3,3,3,3] row_mask:0xf bank_mask:0xf
    v_and_b32_dpp v161, v14, v153 quad_perm:[3,3,3,3] row_mask:0xf bank_mask:0xf
    s_waitcnt vmcnt(18)
    v_mfma_f32_16x16x32_bf16 v[162:165], v[154:157], v[66:69], v[162:165]
    v_and_b32_dpp v154, v15, v150 quad_perm:[0,0,0,0] row_mask:0xf bank_mask:0xf
    v_and_b32_dpp v155, v15, v151 quad_perm:[0,0,0,0] row_mask:0xf bank_mask:0xf
    v_and_b32_dpp v156, v15, v152 quad_perm:[0,0,0,0] row_mask:0xf bank_mask:0xf
    v_and_b32_dpp v157, v15, v153 quad_perm:[0,0,0,0] row_mask:0xf bank_mask:0xf
    s_waitcnt vmcnt(17)
    v_mfma_f32_16x16x32_bf16 v[162:165], v[158:161], v[70:73], v[162:165]
    v_and_b32_dpp v158, v15, v150 quad_perm:[1,1,1,1] row_mask:0xf bank_mask:0xf
    v_and_b32_dpp v159, v15, v151 quad_perm:[1,1,1,1] row_mask:0xf bank_mask:0xf
    v_and_b32_dpp v160, v15, v152 quad_perm:[1,1,1,1] row_mask:0xf bank_mask:0xf
    v_and_b32_dpp v161, v15, v153 quad_perm:[1,1,1,1] row_mask:0xf bank_mask:0xf
    s_waitcnt vmcnt(16)
    v_mfma_f32_16x16x32_bf16 v[162:165], v[154:157], v[74:77], v[162:165]
    v_and_b32_dpp v154, v15, v150 quad_perm:[2,2,2,2] row_mask:0xf bank_mask:0xf
    v_and_b32_dpp v155, v15, v151 quad_perm:[2,2,2,2] row_mask:0xf bank_mask:0xf
    v_and_b32_dpp v156, v15, v152 quad_perm:[2,2,2,2] row_mask:0xf bank_mask:0xf
    v_and_b32_dpp v157, v15, v153 quad_perm:[2,2,2,2] row_mask:0xf bank_mask:0xf
    s_waitcnt vmcnt(15)
    v_mfma_f32_16x16x32_bf16 v[162:165], v[158:161], v[78:81], v[162:165]
    v_and_b32_dpp v158, v15, v150 quad_perm:[3,3,3,3] row_mask:0xf bank_mask:0xf
    v_and_b32_dpp v159, v15, v151 quad_perm:[3,3,3,3] row_mask:0xf bank_mask:0xf
    v_and_b32_dpp v160, v15, v152 quad_perm:[3,3,3,3] row_mask:0xf bank_mask:0xf
    v_and_b32_dpp v161, v15, v153 quad_perm:[3,3,3,3] row_mask:0xf bank_mask:0xf
    s_waitcnt vmcnt(14)
    v_mfma_f32_16x16x32_bf16 v[162:165], v[154:157], v[82:85], v[162:165]
    v_and_b32_dpp v154, v16, v150 quad_perm:[0,0,0,0] row_mask:0xf bank_mask:0xf
    v_and_b32_dpp v155, v16, v151 quad_perm:[0,0,0,0] row_mask:0xf bank_mask:0xf
    v_and_b32_dpp v156, v16, v152 quad_perm:[0,0,0,0] row_mask:0xf bank_mask:0xf
    v_and_b32_dpp v157, v16, v153 quad_perm:[0,0,0,0] row_mask:0xf bank_mask:0xf
    s_waitcnt vmcnt(13)
    v_mfma_f32_16x16x32_bf16 v[162:165], v[158:161], v[86:89], v[162:165]
    v_and_b32_dpp v158, v16, v150 quad_perm:[1,1,1,1] row_mask:0xf bank_mask:0xf
    v_and_b32_dpp v159, v16, v151 quad_perm:[1,1,1,1] row_mask:0xf bank_mask:0xf
    v_and_b32_dpp v160, v16, v152 quad_perm:[1,1,1,1] row_mask:0xf bank_mask:0xf
    v_and_b32_dpp v161, v16, v153 quad_perm:[1,1,1,1] row_mask:0xf bank_mask:0xf
    s_waitcnt vmcnt(12)
    v_mfma_f32_16x16x32_bf16 v[162:165], v[154:157], v[90:93], v[162:165]
    v_and_b32_dpp v154, v16, v150 quad_perm:[2,2,2,2] row_mask:0xf bank_mask:0xf
    v_and_b32_dpp v155, v16, v151 quad_perm:[2,2,2,2] row_mask:0xf bank_mask:0xf
    v_and_b32_dpp v156, v16, v152 quad_perm:[2,2,2,2] row_mask:0xf bank_mask:0xf
    v_and_b32_dpp v157, v16, v153 quad_perm:[2,2,2,2] row_mask:0xf bank_mask:0xf
    s_waitcnt vmcnt(11)
    v_mfma_f32_16x16x32_bf16 v[162:165], v[158:161], v[94:97], v[162:165]
    v_and_b32_dpp v158, v12, v150 quad_perm:[0,0,0,0] row_mask:0xf bank_mask:0xf
    v_and_b32_dpp v159, v12, v151 quad_perm:[0,0,0,0] row_mask:0xf bank_mask:0xf
    v_and_b32_dpp v160, v12, v152 quad_perm:[0,0,0,0] row_mask:0xf bank_mask:0xf
    v_and_b32_dpp v161, v12, v153 quad_perm:[0,0,0,0] row_mask:0xf bank_mask:0xf
    s_waitcnt vmcnt(10)
    v_mfma_f32_16x16x32_bf16 v[162:165], v[154:157], v[98:101], v[162:165]
    v_and_b32_dpp v154, v12, v150 quad_perm:[1,1,1,1] row_mask:0xf bank_mask:0xf
    v_and_b32_dpp v155, v12, v151 quad_perm:[1,1,1,1] row_mask:0xf bank_mask:0xf
    v_and_b32_dpp v156, v12, v152 quad_perm:[1,1,1,1] row_mask:0xf bank_mask:0xf
    v_and_b32_dpp v157, v12, v153 quad_perm:[1,1,1,1] row_mask:0xf bank_mask:0xf
    s_waitcnt vmcnt(9)
    v_mfma_f32_16x16x32_bf16 v[162:165], v[158:161], v[26:29], v[162:165]
    v_and_b32_dpp v158, v12, v150 quad_perm:[2,2,2,2] row_mask:0xf bank_mask:0xf
    v_and_b32_dpp v159, v12, v151 quad_perm:[2,2,2,2] row_mask:0xf bank_mask:0xf
    v_and_b32_dpp v160, v12, v152 quad_perm:[2,2,2,2] row_mask:0xf bank_mask:0xf
    v_and_b32_dpp v161, v12, v153 quad_perm:[2,2,2,2] row_mask:0xf bank_mask:0xf
    s_waitcnt vmcnt(8)
    v_mfma_f32_16x16x32_bf16 v[162:165], v[154:157], v[30:33], v[162:165]
    v_and_b32_dpp v154, v12, v150 quad_perm:[3,3,3,3] row_mask:0xf bank_mask:0xf
    v_and_b32_dpp v155, v12, v151 quad_perm:[3,3,3,3] row_mask:0xf bank_mask:0xf
    v_and_b32_dpp v156, v12, v152 quad_perm:[3,3,3,3] row_mask:0xf bank_mask:0xf
    v_and_b32_dpp v157, v12, v153 quad_perm:[3,3,3,3] row_mask:0xf bank_mask:0xf
    s_waitcnt vmcnt(7)
    v_mfma_f32_16x16x32_bf16 v[162:165], v[158:161], v[34:37], v[162:165]
    v_and_b32_dpp v158, v13, v150 quad_perm:[0,0,0,0] row_mask:0xf bank_mask:0xf
    v_and_b32_dpp v159, v13, v151 quad_perm:[0,0,0,0] row_mask:0xf bank_mask:0xf
    v_and_b32_dpp v160, v13, v152 quad_perm:[0,0,0,0] row_mask:0xf bank_mask:0xf
    v_and_b32_dpp v161, v13, v153 quad_perm:[0,0,0,0] row_mask:0xf bank_mask:0xf
    s_waitcnt vmcnt(6)
    v_mfma_f32_16x16x32_bf16 v[162:165], v[154:157], v[38:41], v[162:165]
    v_and_b32_dpp v154, v13, v150 quad_perm:[1,1,1,1] row_mask:0xf bank_mask:0xf
    v_and_b32_dpp v155, v13, v151 quad_perm:[1,1,1,1] row_mask:0xf bank_mask:0xf
    v_and_b32_dpp v156, v13, v152 quad_perm:[1,1,1,1] row_mask:0xf bank_mask:0xf
    v_and_b32_dpp v157, v13, v153 quad_perm:[1,1,1,1] row_mask:0xf bank_mask:0xf
    s_waitcnt vmcnt(5)
    v_mfma_f32_16x16x32_bf16 v[162:165], v[158:161], v[42:45], v[162:165]
    v_and_b32_dpp v158, v13, v150 quad_perm:[2,2,2,2] row_mask:0xf bank_mask:0xf
    v_and_b32_dpp v159, v13, v151 quad_perm:[2,2,2,2] row_mask:0xf bank_mask:0xf
    v_and_b32_dpp v160, v13, v152 quad_perm:[2,2,2,2] row_mask:0xf bank_mask:0xf
    v_and_b32_dpp v161, v13, v153 quad_perm:[2,2,2,2] row_mask:0xf bank_mask:0xf
    s_waitcnt vmcnt(4)
    v_mfma_f32_16x16x32_bf16 v[162:165], v[154:157], v[46:49], v[162:165]
    v_and_b32_dpp v154, v13, v150 quad_perm:[3,3,3,3] row_mask:0xf bank_mask:0xf
    v_and_b32_dpp v155, v13, v151 quad_perm:[3,3,3,3] row_mask:0xf bank_mask:0xf
    v_and_b32_dpp v156, v13, v152 quad_perm:[3,3,3,3] row_mask:0xf bank_mask:0xf
    v_and_b32_dpp v157, v13, v153 quad_perm:[3,3,3,3] row_mask:0xf bank_mask:0xf
    s_waitcnt vmcnt(3)
    v_mfma_f32_16x16x32_bf16 v[162:165], v[158:161], v[50:53], v[162:165]
    v_and_b32_dpp v158, v14, v150 quad_perm:[0,0,0,0] row_mask:0xf bank_mask:0xf
    v_and_b32_dpp v159, v14, v151 quad_perm:[0,0,0,0] row_mask:0xf bank_mask:0xf
    v_and_b32_dpp v160, v14, v152 quad_perm:[0,0,0,0] row_mask:0xf bank_mask:0xf
    v_and_b32_dpp v161, v14, v153 quad_perm:[0,0,0,0] row_mask:0xf bank_mask:0xf
    s_waitcnt vmcnt(2)
    v_mfma_f32_16x16x32_bf16 v[162:165], v[154:157], v[54:57], v[162:165]
    v_and_b32_dpp v154, v14, v150 quad_perm:[1,1,1,1] row_mask:0xf bank_mask:0xf
    v_and_b32_dpp v155, v14, v151 quad_perm:[1,1,1,1] row_mask:0xf bank_mask:0xf
    v_and_b32_dpp v156, v14, v152 quad_perm:[1,1,1,1] row_mask:0xf bank_mask:0xf
    v_and_b32_dpp v157, v14, v153 quad_perm:[1,1,1,1] row_mask:0xf bank_mask:0xf
    s_waitcnt vmcnt(1)
    v_mfma_f32_16x16x32_bf16 v[162:165], v[158:161], v[58:61], v[162:165]
    s_waitcnt vmcnt(0)
    v_mfma_f32_16x16x32_bf16 v[162:165], v[154:157], v[62:65], v[162:165]
    s_nop 7
    ds_write_b128 v20, v[162:165] offset:1024
    v_mov_b32 v17, 1
    s_mov_b64 exec, 1
    ds_add_rtn_u32 v17, v1, v17 offset:4
    s_mov_b64 exec, -1
    s_waitcnt lgkmcnt(0)
    v_readfirstlane_b32 s81, v17
    s_cmp_lg_u32 s81, 7
    s_nop 2
    s_cbranch_scc1 L_s_end
    ds_read_b128 v[26:29], v3 offset:1024
    ds_read_b128 v[30:33], v3 offset:2048
    ds_read_b128 v[34:37], v3 offset:3072
    ds_read_b128 v[38:41], v3 offset:4096
    ds_read_b128 v[42:45], v3 offset:5120
    ds_read_b128 v[46:49], v3 offset:6144
    ds_read_b128 v[50:53], v3 offset:7168
    ds_read_b128 v[54:57], v3 offset:8192
    v_lshrrev_b32 v24, 1, v3
    s_waitcnt lgkmcnt(6)
    v_pk_add_f32 v[26:27], v[26:27], v[30:31]
    v_pk_add_f32 v[28:29], v[28:29], v[32:33]
    s_waitcnt lgkmcnt(4)
    v_pk_add_f32 v[34:35], v[34:35], v[38:39]
    v_pk_add_f32 v[36:37], v[36:37], v[40:41]
    s_waitcnt lgkmcnt(2)
    v_pk_add_f32 v[42:43], v[42:43], v[46:47]
    v_pk_add_f32 v[44:45], v[44:45], v[48:49]
    s_waitcnt lgkmcnt(0)
    v_pk_add_f32 v[50:51], v[50:51], v[54:55]
    v_pk_add_f32 v[52:53], v[52:53], v[56:57]
    v_pk_add_f32 v[26:27], v[26:27], v[34:35]
    v_pk_add_f32 v[28:29], v[28:29], v[36:37]
    v_pk_add_f32 v[42:43], v[42:43], v[50:51]
    v_pk_add_f32 v[44:45], v[44:45], v[52:53]
    v_pk_add_f32 v[26:27], v[26:27], v[42:43]
    v_pk_add_f32 v[28:29], v[28:29], v[44:45]
    buffer_store_dwordx4 v[26:29], v3, s[12:15], s34 offen sc1
    s_waitcnt lgkmcnt(0)
    v_mov_b32 v17, 1
    s_mov_b64 exec, 1
    ds_add_u32 v1, v17 offset:40
    s_mov_b64 exec, -1
L_s_end:
    s_endpgm
L_chain:
    s_setprio 3
    s_mov_b32 s78, 0x05040100
    s_mov_b32 s79, 0x07060302
    s_waitcnt lgkmcnt(0)
    s_bfe_u32 s83, s100, 0x2000c
    s_bfe_u32 s71, s100, 0x6000e
    s_bfe_u32 s69, s100, 0x20014
    s_bfe_u32 s101, s100, 0x80016
    s_lshl_b32 s74, s3, 1
    s_min_u32 s75, s3, 1
    s_add_u32 s74, s74, s75
    s_mov_b32 s70, 8192
    s_cmp_eq_u32 s83, 2
    s_cselect_b32 s70, 6912, s70
    v_lshrrev_b32 v14, 4, v1
    v_bfe_u32 v2, v1, 2, 1
    v_lshl_add_u32 v14, v14, 1, v2
    v_and_b32 v2, 1, v1
    v_mul_u32_u24 v2, 1152, v2
    v_lshl_add_u32 v6, v14, 4, v2
    v_lshrrev_b32 v3, 3, v1
    v_mul_lo_u32 v3, v3, s70
    v_and_b32 v8, 7, v1
    v_lshlrev_b32 v8, 4, v8
    v_lshl_add_u32 v4, v3, 3, v8
    s_lshl_b32 s72, s71, 7
    s_lshl_b32 s73, s74, 6
    s_mul_i32 s73, s73, s70
    s_add_u32 s73, s73, s72
    s_mul_i32 s75, s70, 56
    s_lshl_b32 s74, s74, 7
    s_waitcnt lgkmcnt(0)
    s_mov_b32 s12, s64
    s_and_b32 s13, s65, 0xffff
    s_mov_b32 s14, 268435456
    s_mov_b32 s15, 0x00020000
    s_cmp_lg_u32 s3, 3
    s_cbranch_scc1 L_c_nopz0
    v_mov_b32 v112, -1
    v_mov_b32 v113, -1
    v_mov_b32 v114, -1
    v_mov_b32 v115, -1
    v_lshlrev_b32 v116, 4, v1
    s_and_b32 s34, s2, 31
    s_lshl_b32 s34, s34, 3
    s_lshr_b32 s35, s2, 5
    s_add_u32 s34, s34, s35
    s_lshl_b32 s34, s34, 10
    s_add_u32 s34, s34, 65536
    v_lshlrev_b32 v117, 3, v1
    buffer_store_dwordx4 v[112:115], v116, s[12:15], s34 offen sc1
    s_cmp_lg_u32 s69, 1
    s_cbranch_scc1 L_pz_o
    s_mul_i32 s35, s101, 4608
    s_add_u32 s35, s35, 393216
    buffer_store_dwordx4 v[112:115], v116, s[12:15], s35 offen sc1
    buffer_store_dwordx4 v[112:115], v116, s[12:15], s35 offen offset:1024 sc1
    buffer_store_dwordx4 v[112:115], v116, s[12:15], s35 offen offset:2048 sc1
    buffer_store_dwordx4 v[112:115], v116, s[12:15], s35 offen offset:3072 sc1
    s_add_u32 s35, s35, 4096
    s_mov_b32 exec_hi, 0
    buffer_store_dwordx4 v[112:115], v116, s[12:15], s35 offen sc1
    s_mov_b64 exec, -1
    s_branch L_pz_done
L_pz_o:
    s_cmp_lg_u32 s69, 2
    s_cbranch_scc1 L_pz_done
    s_mov_b32 s35, s101
    s_mul_i32 s66, s35, 57
    s_lshr_b32 s66, s66, 9
    s_mul_i32 s67, s66, 9
    s_sub_u32 s67, s35, s67
    s_mul_i32 s35, s66, 2304
    s_lshl_b32 s67, s67, 7
    s_add_u32 s35, s35, s67
    s_add_u32 s35, s35, 1114112
    v_and_b32 v117, 31, v1
    v_lshlrev_b32 v117, 2, v117
    v_lshrrev_b32 v118, 5, v1
    v_mul_u32_u24 v118, 1152, v118
    v_add_u32 v117, v117, v118
    buffer_store_dword v112, v117, s[12:15], s35 offen sc1
    s_add_u32 s35, s35, 20480
L_pz_done:
L_c_nopz0:
    s_mov_b32 s76, 389120
    s_cmp_eq_u32 s83, 0
    s_cbranch_scc1 L_nohead0
    s_cmp_eq_u32 s83, 2
    s_cselect_b32 s20, s58, s42
    s_cselect_b32 s21, s59, s43
    s_mov_b32 s22, 4718592
    s_cselect_b32 s22, 3981312, s22
    s_mov_b32 s23, 0x00020000
    s_cselect_b32 s28, s56, s36
    s_cselect_b32 s29, s57, s37
    s_mov_b32 s30, 2304
    s_mov_b32 s31, 0x00020000
    buffer_load_dwordx4 v[144:147], v6, s[28:31], s74 offen
    buffer_load_dwordx4 v[148:151], v6, s[28:31], s74 offen offset:128
    buffer_load_dwordx4 v[152:155], v6, s[28:31], s74 offen offset:256
    buffer_load_dwordx2 v[12:13], v0, s[12:15], s76 offen sc1
    s_cbranch_scc1 L_h_w
    v_lshrrev_b32 v2, 5, v1
    v_mul_u32_u24 v2, 1152, v2
    v_and_b32 v3, 31, v1
    v_lshl_add_u32 v2, v3, 4, v2
    buffer_load_dwordx4 v[156:159], v2, s[28:31], 0 offen
    buffer_load_dwordx4 v[160:163], v2, s[28:31], 0 offen offset:512
    v_mov_b32 v164, 0
    v_mov_b32 v165, 0
    v_mov_b32 v166, 0
    v_mov_b32 v167, 0
    s_mov_b32 exec_lo, 0xff
    s_mov_b32 exec_hi, 0xff
    buffer_load_dwordx4 v[164:167], v2, s[28:31], 0 offen offset:1024
    s_mov_b64 exec, -1
L_h_w:
    buffer_load_dwordx4 v[16:19], v4, s[20:23], s73 offen nt
    s_add_u32 s73, s73, s70
    buffer_load_dwordx4 v[20:23], v4, s[20:23], s73 offen nt
    s_add_u32 s73, s73, s70
    buffer_load_dwordx4 v[24:27], v4, s[20:23], s73 offen nt
    s_add_u32 s73, s73, s70
    buffer_load_dwordx4 v[28:31], v4, s[20:23], s73 offen nt
    s_add_u32 s73, s73, s70
    buffer_load_dwordx4 v[32:35], v4, s[20:23], s73 offen nt
    s_add_u32 s73, s73, s70
    buffer_load_dwordx4 v[36:39], v4, s[20:23], s73 offen nt
    s_add_u32 s73, s73, s70
    buffer_load_dwordx4 v[40:43], v4, s[20:23], s73 offen nt
    s_add_u32 s73, s73, s70
    buffer_load_dwordx4 v[44:47], v4, s[20:23], s73 offen nt
    s_add_u32 s73, s73, s70
    s_add_u32 s73, s73, s75
    s_barrier
    buffer_load_dwordx4 v[48:51], v4, s[20:23], s73 offen nt
    s_add_u32 s73, s73, s70
    buffer_load_dwordx4 v[52:55], v4, s[20:23], s73 offen nt
    s_add_u32 s73, s73, s70
    buffer_load_dwordx4 v[56:59], v4, s[20:23], s73 offen nt
    s_add_u32 s73, s73, s70
    buffer_load_dwordx4 v[60:63], v4, s[20:23], s73 offen nt
    s_add_u32 s73, s73, s70
    buffer_load_dwordx4 v[64:67], v4, s[20:23], s73 offen nt
    s_add_u32 s73, s73, s70
    buffer_load_dwordx4 v[68:71], v4, s[20:23], s73 offen nt
    s_add_u32 s73, s73, s70
    buffer_load_dwordx4 v[72:75], v4, s[20:23], s73 offen nt
    s_add_u32 s73, s73, s70
    buffer_load_dwordx4 v[76:79], v4, s[20:23], s73 offen nt
    s_add_u32 s73, s73, s70
    s_add_u32 s73, s73, s75
    s_cmp_lg_u32 s3, 0
    s_cbranch_scc1 L_h_w2
    buffer_load_dwordx4 v[80:83], v4, s[20:23], s73 offen nt
    s_add_u32 s73, s73, s70
    buffer_load_dwordx4 v[84:87], v4, s[20:23], s73 offen nt
    s_add_u32 s73, s73, s70
    buffer_load_dwordx4 v[88:91], v4, s[20:23], s73 offen nt
    s_add_u32 s73, s73, s70
    buffer_load_dwordx4 v[92:95], v4, s[20:23], s73 offen nt
    s_add_u32 s73, s73, s70
    buffer_load_dwordx4 v[96:99], v4, s[20:23], s73 offen nt
    s_add_u32 s73, s73, s70
    buffer_load_dwordx4 v[100:103], v4, s[20:23], s73 offen nt
    s_add_u32 s73, s73, s70
    buffer_load_dwordx4 v[104:107], v4, s[20:23], s73 offen nt
    s_add_u32 s73, s73, s70
    buffer_load_dwordx4 v[108:111], v4, s[20:23], s73 offen nt
    s_add_u32 s73, s73, s70
L_h_w2:
    s_waitcnt vmcnt(16)
    v_readfirstlane_b32 s32, v12
    v_readfirstlane_b32 s33, v13
    s_add_u32 s32, s32, 1
    s_addc_u32 s33, s33, 0
    s_cmp_eq_u32 s83, 1
    s_nop 0
    s_cbranch_scc1 L_hq
    s_mov_b32 s82, 0xbfb8aa3b
    v_and_b32 v3, 0xffff0000, v144
    v_lshlrev_b32 v2, 16, v144
    v_and_b32 v5, 0xffff0000, v145
    v_lshlrev_b32 v4, 16, v145
    v_mul_f32 v6, s82, v2
    v_mul_f32 v7, s82, v3
    v_mul_f32 v8, s82, v4
    v_mul_f32 v9, s82, v5
    v_exp_f32 v6, v6
    v_exp_f32 v7, v7
    v_exp_f32 v8, v8
    v_exp_f32 v9, v9
    v_add_f32 v6, 1.0, v6
    v_add_f32 v7, 1.0, v7
    v_add_f32 v8, 1.0, v8
    v_add_f32 v9, 1.0, v9
    v_rcp_f32 v6, v6
    v_rcp_f32 v7, v7
    v_rcp_f32 v8, v8
    v_rcp_f32 v9, v9
    v_mul_f32 v2, v2, v6
    v_mul_f32 v3, v3, v7
    v_mul_f32 v4, v4, v8
    v_mul_f32 v5, v5, v9
    v_cvt_pk_bf16_f32 v144, v2, v3
    v_cvt_pk_bf16_f32 v145, v4, v5
    v_and_b32 v3, 0xffff0000, v146
    v_lshlrev_b32 v2, 16, v146
    v_and_b32 v5, 0xffff0000, v147
    v_lshlrev_b32 v4, 16, v147
    v_mul_f32 v6, s82, v2
    v_mul_f32 v7, s82, v3
    v_mul_f32 v8, s82, v4
    v_mul_f32 v9, s82, v5
    v_exp_f32 v6, v6
    v_exp_f32 v7, v7
    v_exp_f32 v8, v8
    v_exp_f32 v9, v9
    v_add_f32 v6, 1.0, v6
    v_add_f32 v7, 1.0, v7
    v_add_f32 v8, 1.0, v8
    v_add_f32 v9, 1.0, v9
    v_rcp_f32 v6, v6
    v_rcp_f32 v7, v7
    v_rcp_f32 v8, v8
    v_rcp_f32 v9, v9
    v_mul_f32 v2, v2, v6
    v_mul_f32 v3, v3, v7
    v_mul_f32 v4, v4, v8
    v_mul_f32 v5, v5, v9
    v_cvt_pk_bf16_f32 v146, v2, v3
    v_cvt_pk_bf16_f32 v147, v4, v5
    v_and_b32 v3, 0xffff0000, v148
    v_lshlrev_b32 v2, 16, v148
    v_and_b32 v5, 0xffff0000, v149
    v_lshlrev_b32 v4, 16, v149
    v_mul_f32 v6, s82, v2
    v_mul_f32 v7, s82, v3
    v_mul_f32 v8, s82, v4
    v_mul_f32 v9, s82, v5
    v_exp_f32 v6, v6
    v_exp_f32 v7, v7
    v_exp_f32 v8, v8
    v_exp_f32 v9, v9
    v_add_f32 v6, 1.0, v6
    v_add_f32 v7, 1.0, v7
    v_add_f32 v8, 1.0, v8
    v_add_f32 v9, 1.0, v9
    v_rcp_f32 v6, v6
    v_rcp_f32 v7, v7
    v_rcp_f32 v8, v8
    v_rcp_f32 v9, v9
    v_mul_f32 v2, v2, v6
    v_mul_f32 v3, v3, v7
    v_mul_f32 v4, v4, v8
    v_mul_f32 v5, v5, v9
    v_cvt_pk_bf16_f32 v148, v2, v3
    v_cvt_pk_bf16_f32 v149, v4, v5
    v_and_b32 v3, 0xffff0000, v150
    v_lshlrev_b32 v2, 16, v150
    v_and_b32 v5, 0xffff0000, v151
    v_lshlrev_b32 v4, 16, v151
    v_mul_f32 v6, s82, v2
    v_mul_f32 v7, s82, v3
    v_mul_f32 v8, s82, v4
    v_mul_f32 v9, s82, v5
    v_exp_f32 v6, v6
    v_exp_f32 v7, v7
    v_exp_f32 v8, v8
    v_exp_f32 v9, v9
    v_add_f32 v6, 1.0, v6
    v_add_f32 v7, 1.0, v7
    v_add_f32 v8, 1.0, v8
    v_add_f32 v9, 1.0, v9
    v_rcp_f32 v6, v6
    v_rcp_f32 v7, v7
    v_rcp_f32 v8, v8
    v_rcp_f32 v9, v9
    v_mul_f32 v2, v2, v6
    v_mul_f32 v3, v3, v7
    v_mul_f32 v4, v4, v8
    v_mul_f32 v5, v5, v9
    v_cvt_pk_bf16_f32 v150, v2, v3
    v_cvt_pk_bf16_f32 v151, v4, v5
    v_and_b32 v3, 0xffff0000, v152
    v_lshlrev_b32 v2, 16, v152
    v_and_b32 v5, 0xffff0000, v153
    v_lshlrev_b32 v4, 16, v153
    v_mul_f32 v6, s82, v2
    v_mul_f32 v7, s82, v3
    v_mul_f32 v8, s82, v4
    v_mul_f32 v9, s82, v5
    v_exp_f32 v6, v6
    v_exp_f32 v7, v7
    v_exp_f32 v8, v8
    v_exp_f32 v9, v9
    v_add_f32 v6, 1.0, v6
    v_add_f32 v7, 1.0, v7
    v_add_f32 v8, 1.0, v8
    v_add_f32 v9, 1.0, v9
    v_rcp_f32 v6, v6
    v_rcp_f32 v7, v7
    v_rcp_f32 v8, v8
    v_rcp_f32 v9, v9
    v_mul_f32 v2, v2, v6
    v_mul_f32 v3, v3, v7
    v_mul_f32 v4, v4, v8
    v_mul_f32 v5, v5, v9
    v_cvt_pk_bf16_f32 v152, v2, v3
    v_cvt_pk_bf16_f32 v153, v4, v5
    v_and_b32 v3, 0xffff0000, v154
    v_lshlrev_b32 v2, 16, v154
    v_and_b32 v5, 0xffff0000, v155
    v_lshlrev_b32 v4, 16, v155
    v_mul_f32 v6, s82, v2
    v_mul_f32 v7, s82, v3
    v_mul_f32 v8, s82, v4
    v_mul_f32 v9, s82, v5
    v_exp_f32 v6, v6
    v_exp_f32 v7, v7
    v_exp_f32 v8, v8
    v_exp_f32 v9, v9
    v_add_f32 v6, 1.0, v6
    v_add_f32 v7, 1.0, v7
    v_add_f32 v8, 1.0, v8
    v_add_f32 v9, 1.0, v9
    v_rcp_f32 v6, v6
    v_rcp_f32 v7, v7
    v_rcp_f32 v8, v8
    v_rcp_f32 v9, v9
    v_mul_f32 v2, v2, v6
    v_mul_f32 v3, v3, v7
    v_mul_f32 v4, v4, v8
    v_mul_f32 v5, v5, v9
    v_cvt_pk_bf16_f32 v154, v2, v3
    v_cvt_pk_bf16_f32 v155, v4, v5
    s_waitcnt vmcnt(8)
    v_perm_b32 v2, v20, v16, s78
    v_perm_b32 v20, v20, v16, s79
    v_mov_b32 v16, v2
    v_perm_b32 v2, v28, v24, s78
    v_perm_b32 v3, v28, v24, s79
    v_perm_b32 v24, v21, v17, s78
    v_perm_b32 v28, v21, v17, s79
    v_mov_b32 v17, v2
    v_mov_b32 v21, v3
    v_perm_b32 v2, v36, v32, s78
    v_perm_b32 v3, v36, v32, s79
    v_perm_b32 v32, v22, v18, s78
    v_perm_b32 v36, v22, v18, s79
    v_mov_b32 v18, v2
    v_mov_b32 v22, v3
    v_perm_b32 v2, v44, v40, s78
    v_perm_b32 v3, v44, v40, s79
    v_perm_b32 v40, v23, v19, s78
    v_perm_b32 v44, v23, v19, s79
    v_mov_b32 v19, v2
    v_mov_b32 v23, v3
    v_perm_b32 v2, v29, v25, s78
    v_perm_b32 v29, v29, v25, s79
    v_mov_b32 v25, v2
    v_perm_b32 v2, v37, v33, s78
    v_perm_b32 v3, v37, v33, s79
    v_perm_b32 v33, v30, v26, s78
    v_perm_b32 v37, v30, v26, s79
    v_mov_b32 v26, v2
    v_mov_b32 v30, v3
    v_perm_b32 v2, v45, v41, s78
    v_perm_b32 v3, v45, v41, s79
    v_perm_b32 v41, v31, v27, s78
    v_perm_b32 v45, v31, v27, s79
    v_mov_b32 v27, v2
    v_mov_b32 v31, v3
    v_perm_b32 v2, v38, v34, s78
    v_perm_b32 v38, v38, v34, s79
    v_mov_b32 v34, v2
    v_perm_b32 v2, v46, v42, s78
    v_perm_b32 v3, v46, v42, s79
    v_perm_b32 v42, v39, v35, s78
    v_perm_b32 v46, v39, v35, s79
    v_mov_b32 v35, v2
    v_mov_b32 v39, v3
    v_perm_b32 v2, v47, v43, s78
    v_perm_b32 v47, v47, v43, s79
    v_mov_b32 v43, v2
    s_waitcnt vmcnt(0)
    v_perm_b32 v2, v52, v48, s78
    v_perm_b32 v52, v52, v48, s79
    v_mov_b32 v48, v2
    v_perm_b32 v2, v60, v56, s78
    v_perm_b32 v3, v60, v56, s79
    v_perm_b32 v56, v53, v49, s78
    v_perm_b32 v60, v53, v49, s79
    v_mov_b32 v49, v2
    v_mov_b32 v53, v3
    v_perm_b32 v2, v68, v64, s78
    v_perm_b32 v3, v68, v64, s79
    v_perm_b32 v64, v54, v50, s78
    v_perm_b32 v68, v54, v50, s79
    v_mov_b32 v50, v2
    v_mov_b32 v54, v3
    v_perm_b32 v2, v76, v72, s78
    v_perm_b32 v3, v76, v72, s79
    v_perm_b32 v72, v55, v51, s78
    v_perm_b32 v76, v55, v51, s79
    v_mov_b32 v51, v2
    v_mov_b32 v55, v3
    v_perm_b32 v2, v61, v57, s78
    v_perm_b32 v61, v61, v57, s79
    v_mov_b32 v57, v2
    v_perm_b32 v2, v69, v65, s78
    v_perm_b32 v3, v69, v65, s79
    v_perm_b32 v65, v62, v58, s78
    v_perm_b32 v69, v62, v58, s79
    v_mov_b32 v58, v2
    v_mov_b32 v62, v3
    v_perm_b32 v2, v77, v73, s78
    v_perm_b32 v3, v77, v73, s79
    v_perm_b32 v73, v63, v59, s78
    v_perm_b32 v77, v63, v59, s79
    v_mov_b32 v59, v2
    v_mov_b32 v63, v3
    v_perm_b32 v2, v70, v66, s78
    v_perm_b32 v70, v70, v66, s79
    v_mov_b32 v66, v2
    v_perm_b32 v2, v78, v74, s78
    v_perm_b32 v3, v78, v74, s79
    v_perm_b32 v74, v71, v67, s78
    v_perm_b32 v78, v71, v67, s79
    v_mov_b32 v67, v2
    v_mov_b32 v71, v3
    v_perm_b32 v2, v79, v75, s78
    v_perm_b32 v79, v79, v75, s79
    v_mov_b32 v75, v2
    s_cmp_lg_u32 s3, 0
    s_cbranch_scc1 HT_1
    v_perm_b32 v2, v84, v80, s78
    v_perm_b32 v84, v84, v80, s79
    v_mov_b32 v80, v2
    v_perm_b32 v2, v92, v88, s78
    v_perm_b32 v3, v92, v88, s79
    v_perm_b32 v88, v85, v81, s78
    v_perm_b32 v92, v85, v81, s79
    v_mov_b32 v81, v2
    v_mov_b32 v85, v3
    v_perm_b32 v2, v100, v96, s78
    v_perm_b32 v3, v100, v96, s79
    v_perm_b32 v96, v86, v82, s78
    v_perm_b32 v100, v86, v82, s79
    v_mov_b32 v82, v2
    v_mov_b32 v86, v3
    v_perm_b32 v2, v108, v104, s78
    v_perm_b32 v3, v108, v104, s79
    v_perm_b32 v104, v87, v83, s78
    v_perm_b32 v108, v87, v83, s79
    v_mov_b32 v83, v2
    v_mov_b32 v87, v3
    v_perm_b32 v2, v93, v89, s78
    v_perm_b32 v93, v93, v89, s79
    v_mov_b32 v89, v2
    v_perm_b32 v2, v101, v97, s78
    v_perm_b32 v3, v101, v97, s79
    v_perm_b32 v97, v94, v90, s78
    v_perm_b32 v101, v94, v90, s79
    v_mov_b32 v90, v2
    v_mov_b32 v94, v3
    v_perm_b32 v2, v109, v105, s78
    v_perm_b32 v3, v109, v105, s79
    v_perm_b32 v105, v95, v91, s78
    v_perm_b32 v109, v95, v91, s79
    v_mov_b32 v91, v2
    v_mov_b32 v95, v3
    v_perm_b32 v2, v102, v98, s78
    v_perm_b32 v102, v102, v98, s79
    v_mov_b32 v98, v2
    v_perm_b32 v2, v110, v106, s78
    v_perm_b32 v3, v110, v106, s79
    v_perm_b32 v106, v103, v99, s78
    v_perm_b32 v110, v103, v99, s79
    v_mov_b32 v99, v2
    v_mov_b32 v103, v3
    v_perm_b32 v2, v111, v107, s78
    v_perm_b32 v111, v111, v107, s79
    v_mov_b32 v107, v2
HT_1:
L_hgemv:
    v_mfma_f32_16x16x32_bf16 v[112:115], v[144:147], v[16:19], 0
    v_mfma_f32_16x16x32_bf16 v[116:119], v[144:147], v[20:23], 0
    v_mfma_f32_16x16x32_bf16 v[120:123], v[144:147], v[24:27], 0
    v_mfma_f32_16x16x32_bf16 v[124:127], v[144:147], v[28:31], 0
    v_mfma_f32_16x16x32_bf16 v[128:131], v[144:147], v[32:35], 0
    v_mfma_f32_16x16x32_bf16 v[132:135], v[144:147], v[36:39], 0
    v_mfma_f32_16x16x32_bf16 v[136:139], v[144:147], v[40:43], 0
    v_mfma_f32_16x16x32_bf16 v[140:143], v[144:147], v[44:47], 0
    v_mfma_f32_16x16x32_bf16 v[112:115], v[148:151], v[48:51], v[112:115]
    v_mfma_f32_16x16x32_bf16 v[116:119], v[148:151], v[52:55], v[116:119]
    v_mfma_f32_16x16x32_bf16 v[120:123], v[148:151], v[56:59], v[120:123]
    v_mfma_f32_16x16x32_bf16 v[124:127], v[148:151], v[60:63], v[124:127]
    v_mfma_f32_16x16x32_bf16 v[128:131], v[148:151], v[64:67], v[128:131]
    v_mfma_f32_16x16x32_bf16 v[132:135], v[148:151], v[68:71], v[132:135]
    v_mfma_f32_16x16x32_bf16 v[136:139], v[148:151], v[72:75], v[136:139]
    v_mfma_f32_16x16x32_bf16 v[140:143], v[148:151], v[76:79], v[140:143]
    s_cmp_lg_u32 s3, 0
    s_nop 5
    s_cbranch_scc1 L_hg2
    v_mfma_f32_16x16x32_bf16 v[112:115], v[152:155], v[80:83], v[112:115]
    v_mfma_f32_16x16x32_bf16 v[116:119], v[152:155], v[84:87], v[116:119]
    v_mfma_f32_16x16x32_bf16 v[120:123], v[152:155], v[88:91], v[120:123]
    v_mfma_f32_16x16x32_bf16 v[124:127], v[152:155], v[92:95], v[124:127]
    v_mfma_f32_16x16x32_bf16 v[128:131], v[152:155], v[96:99], v[128:131]
    v_mfma_f32_16x16x32_bf16 v[132:135], v[152:155], v[100:103], v[132:135]
    v_mfma_f32_16x16x32_bf16 v[136:139], v[152:155], v[104:107], v[136:139]
    v_mfma_f32_16x16x32_bf16 v[140:143], v[152:155], v[108:111], v[140:143]
L_hg2:
    v_and_b32 v2, 7, v1
    v_lshlrev_b32 v2, 6, v2
    v_lshrrev_b32 v3, 4, v1
    v_lshl_add_u32 v2, v3, 9, v2
    s_lshl_b32 s72, s3, 10
    v_add_u32 v2, s72, v2
    v_lshlrev_b32 v9, 3, v1
    s_mov_b32 exec_lo, 0xff0000ff
    s_mov_b32 exec_hi, 0
    ds_write_b64 v2, v[112:113] offset:9216
    ds_write_b64 v2, v[116:117] offset:9224
    ds_write_b64 v2, v[120:121] offset:9232
    ds_write_b64 v2, v[124:125] offset:9240
    ds_write_b64 v2, v[128:129] offset:9248
    ds_write_b64 v2, v[132:133] offset:9256
    ds_write_b64 v2, v[136:137] offset:9264
    ds_write_b64 v2, v[140:141] offset:9272
    s_mov_b64 exec, -1
    v_mov_b32 v2, 1
    s_mov_b64 exec, 1
    ds_add_rtn_u32 v2, v0, v2 offset:16
    s_mov_b64 exec, -1
    s_waitcnt lgkmcnt(0)
    v_readfirstlane_b32 s81, v2
    s_cmp_lg_u32 s81, 3
    s_nop 2
    s_cbranch_scc1 L_head_done
    ds_read_b64 v[16:17], v9 offset:9216
    ds_read_b64 v[18:19], v9 offset:9728
    ds_read_b64 v[20:21], v9 offset:10240
    ds_read_b64 v[22:23], v9 offset:10752
    ds_read_b64 v[24:25], v9 offset:11264
    ds_read_b64 v[26:27], v9 offset:11776
    ds_read_b64 v[28:29], v9 offset:12288
    ds_read_b64 v[30:31], v9 offset:12800
    s_waitcnt lgkmcnt(6)
    v_pk_add_f32 v[16:17], v[16:17], v[18:19]
    s_waitcnt lgkmcnt(4)
    v_pk_add_f32 v[20:21], v[20:21], v[22:23]
    s_waitcnt lgkmcnt(2)
    v_pk_add_f32 v[24:25], v[24:25], v[26:27]
    s_waitcnt lgkmcnt(0)
    v_pk_add_f32 v[28:29], v[28:29], v[30:31]
    v_pk_add_f32 v[16:17], v[16:17], v[20:21]
    v_pk_add_f32 v[24:25], v[24:25], v[28:29]
    v_pk_add_f32 v[16:17], v[16:17], v[24:25]
    v_mov_b32 v6, s32
    v_mov_b32 v7, s33
    s_cmp_eq_u32 s83, 2
    s_cbranch_scc1 L_hs_m
    v_mov_b32 v10, s32
    v_mov_b32 v11, s33
    v_mov_b32_dpp v2, v16 quad_perm:[1,0,3,2] row_mask:0xf bank_mask:0xf
    v_mov_b32_dpp v3, v17 quad_perm:[1,0,3,2] row_mask:0xf bank_mask:0xf
    v_cvt_pk_bf16_f32 v4, v16, v2
    v_cvt_pk_bf16_f32 v8, v17, v3
    s_nop 0
    v_mov_b32_dpp v5, v4 quad_perm:[2,3,0,1] row_mask:0xf bank_mask:0xf
    v_mov_b32_dpp v9, v8 quad_perm:[2,3,0,1] row_mask:0xf bank_mask:0xf
    v_lshlrev_b32 v2, 2, v1
    s_lshl_b32 s72, s71, 8
    s_add_u32 s72, s72, 32768
    s_add_u32 s73, s72, 16384
    s_mov_b32 exec_lo, 0x11111111
    s_mov_b32 exec_hi, 0x11111111
    buffer_store_dwordx4 v[4:7], v2, s[12:15], s72 offen sc1
    buffer_store_dwordx4 v[8:11], v2, s[12:15], s73 offen sc1
    s_mov_b64 exec, 1
    v_mov_b32 v2, 1
    ds_write_b32 v0, v2 offset:52
    s_mov_b64 exec, -1
    s_branch L_head_done
L_hs_m:
    v_cvt_pk_bf16_f32 v4, v16, v17
    s_cmp_ge_u32 s71, 18
    s_cbranch_scc1 L_hs_m2
    v_mov_b32_dpp v5, v4 quad_perm:[1,0,3,2] row_mask:0xf bank_mask:0xf
    s_lshl_b32 s72, s71, 9
    s_add_u32 s72, s72, 0
    s_mov_b32 exec_lo, 0x55555555
    s_mov_b32 exec_hi, 0x55555555
    buffer_store_dwordx4 v[4:7], v9, s[12:15], s72 offen sc1
    s_mov_b64 exec, 1
    v_mov_b32 v2, 1
    ds_write_b32 v0, v2 offset:52
    s_mov_b64 exec, -1
    s_branch L_head_done
L_hs_m2:
    v_lshlrev_b32 v2, 2, v1
    s_lshl_b32 s72, s71, 8
    s_add_u32 s72, s72, 11776
    buffer_store_dword v4, v2, s[12:15], s72 offen sc1
    s_waitcnt vmcnt(0)
    s_waitcnt lgkmcnt(0)
    v_mov_b32 v2, 1
    s_mov_b64 exec, 1
    ds_add_u32 v0, v2 offset:32
    s_mov_b64 exec, -1
    s_branch L_head_done
L_hq:
    v_and_b32 v113, 0xffff0000, v156
    v_lshlrev_b32 v112, 16, v156
    v_and_b32 v115, 0xffff0000, v157
    v_lshlrev_b32 v114, 16, v157
    v_and_b32 v117, 0xffff0000, v158
    v_lshlrev_b32 v116, 16, v158
    v_and_b32 v119, 0xffff0000, v159
    v_lshlrev_b32 v118, 16, v159
    v_and_b32 v121, 0xffff0000, v160
    v_lshlrev_b32 v120, 16, v160
    v_and_b32 v123, 0xffff0000, v161
    v_lshlrev_b32 v122, 16, v161
    v_and_b32 v125, 0xffff0000, v162
    v_lshlrev_b32 v124, 16, v162
    v_and_b32 v127, 0xffff0000, v163
    v_lshlrev_b32 v126, 16, v163
    v_and_b32 v129, 0xffff0000, v164
    v_lshlrev_b32 v128, 16, v164
    v_and_b32 v131, 0xffff0000, v165
    v_lshlrev_b32 v130, 16, v165
    v_and_b32 v133, 0xffff0000, v166
    v_lshlrev_b32 v132, 16, v166
    v_and_b32 v135, 0xffff0000, v167
    v_lshlrev_b32 v134, 16, v167
    v_pk_add_f32 v[2:3], v[112:113], v[114:115]
    v_pk_add_f32 v[2:3], v[2:3], v[116:117]
    v_pk_add_f32 v[2:3], v[2:3], v[118:119]
    v_pk_add_f32 v[2:3], v[2:3], v[120:121]
    v_pk_add_f32 v[2:3], v[2:3], v[122:123]
    v_pk_add_f32 v[2:3], v[2:3], v[124:125]
    v_pk_add_f32 v[2:3], v[2:3], v[126:127]
    v_pk_add_f32 v[2:3], v[2:3], v[128:129]
    v_pk_add_f32 v[2:3], v[2:3], v[130:131]
    v_pk_add_f32 v[2:3], v[2:3], v[132:133]
    v_pk_add_f32 v[2:3], v[2:3], v[134:135]
    v_add_f32 v2, v2, v3
    s_nop 1
    v_add_f32_dpp v2, v2, v2 row_ror:8 row_mask:0xf bank_mask:0xf
    s_nop 1
    v_add_f32_dpp v2, v2, v2 row_ror:4 row_mask:0xf bank_mask:0xf
    s_nop 1
    v_add_f32_dpp v2, v2, v2 row_ror:2 row_mask:0xf bank_mask:0xf
    s_nop 1
    v_add_f32_dpp v2, v2, v2 row_ror:1 row_mask:0xf bank_mask:0xf
    v_mov_b32 v3, v2
    s_nop 1
    v_permlane16_swap_b32 v2, v3
    v_add_f32 v2, v2, v3
    s_mov_b32 s82, 0x3ae38e39
    v_mul_f32 v2, s82, v2
    v_and_b32 v4, 31, v1
    v_cmp_gt_u32 vcc, 8, v4
    v_sub_f32 v112, v112, v2
    v_sub_f32 v113, v113, v2
    v_sub_f32 v114, v114, v2
    v_sub_f32 v115, v115, v2
    v_sub_f32 v116, v116, v2
    v_sub_f32 v117, v117, v2
    v_sub_f32 v118, v118, v2
    v_sub_f32 v119, v119, v2
    v_sub_f32 v120, v120, v2
    v_sub_f32 v121, v121, v2
    v_sub_f32 v122, v122, v2
    v_sub_f32 v123, v123, v2
    v_sub_f32 v124, v124, v2
    v_sub_f32 v125, v125, v2
    v_sub_f32 v126, v126, v2
    v_sub_f32 v127, v127, v2
    v_sub_f32 v128, v128, v2
    v_sub_f32 v129, v129, v2
    v_sub_f32 v130, v130, v2
    v_sub_f32 v131, v131, v2
    v_sub_f32 v132, v132, v2
    v_sub_f32 v133, v133, v2
    v_sub_f32 v134, v134, v2
    v_sub_f32 v135, v135, v2
    v_cndmask_b32 v128, 0, v128, vcc
    v_cndmask_b32 v129, 0, v129, vcc
    v_cndmask_b32 v130, 0, v130, vcc
    v_cndmask_b32 v131, 0, v131, vcc
    v_cndmask_b32 v132, 0, v132, vcc
    v_cndmask_b32 v133, 0, v133, vcc
    v_cndmask_b32 v134, 0, v134, vcc
    v_cndmask_b32 v135, 0, v135, vcc
    v_mul_f32 v3, v112, v112
    v_fmac_f32 v3, v113, v113
    v_fmac_f32 v3, v114, v114
    v_fmac_f32 v3, v115, v115
    v_fmac_f32 v3, v116, v116
    v_fmac_f32 v3, v117, v117
    v_fmac_f32 v3, v118, v118
    v_fmac_f32 v3, v119, v119
    v_fmac_f32 v3, v120, v120
    v_fmac_f32 v3, v121, v121
    v_fmac_f32 v3, v122, v122
    v_fmac_f32 v3, v123, v123
    v_fmac_f32 v3, v124, v124
    v_fmac_f32 v3, v125, v125
    v_fmac_f32 v3, v126, v126
    v_fmac_f32 v3, v127, v127
    v_fmac_f32 v3, v128, v128
    v_fmac_f32 v3, v129, v129
    v_fmac_f32 v3, v130, v130
    v_fmac_f32 v3, v131, v131
    v_fmac_f32 v3, v132, v132
    v_fmac_f32 v3, v133, v133
    v_fmac_f32 v3, v134, v134
    v_fmac_f32 v3, v135, v135
    s_nop 1
    v_add_f32_dpp v3, v3, v3 row_ror:8 row_mask:0xf bank_mask:0xf
    s_nop 1
    v_add_f32_dpp v3, v3, v3 row_ror:4 row_mask:0xf bank_mask:0xf
    s_nop 1
    v_add_f32_dpp v3, v3, v3 row_ror:2 row_mask:0xf bank_mask:0xf
    s_nop 1
    v_add_f32_dpp v3, v3, v3 row_ror:1 row_mask:0xf bank_mask:0xf
    v_mov_b32 v4, v3
    s_nop 1
    v_permlane16_swap_b32 v3, v4
    v_add_f32 v3, v3, v4
    v_mul_f32 v3, s82, v3
    v_cvt_pk_bf16_f32 v4, v2, v3
    v_lshlrev_b32 v2, 16, v4
    v_and_b32 v3, 0xffff0000, v4
    v_add_f32 v3, 0x3727c5ac, v3
    v_cvt_pk_bf16_f32 v4, v3, v3
    v_lshlrev_b32 v3, 16, v4
    v_sqrt_f32 v3, v3
    s_nop 0
    v_cvt_pk_bf16_f32 v4, v3, v3
    v_lshlrev_b32 v3, 16, v4
    v_rcp_f32 v3, v3
    v_readlane_b32 s72, v2, 0
    v_readlane_b32 s73, v2, 32
    v_readlane_b32 s76, v3, 0
    v_readlane_b32 s75, v3, 32
    s_mov_b32 s66, 0xaaaaaaaa
    s_mov_b32 s67, 0xaaaaaaaa
    v_mov_b32 v12, s72
    v_mov_b32 v13, s73
    v_cndmask_b32 v12, v12, v13, s[66:67]
    v_mov_b32 v13, s76
    v_mov_b32 v2, s75
    v_cndmask_b32 v13, v13, v2, s[66:67]
    v_and_b32 v113, 0xffff0000, v144
    v_lshlrev_b32 v112, 16, v144
    v_and_b32 v115, 0xffff0000, v145
    v_lshlrev_b32 v114, 16, v145
    v_and_b32 v117, 0xffff0000, v146
    v_lshlrev_b32 v116, 16, v146
    v_and_b32 v119, 0xffff0000, v147
    v_lshlrev_b32 v118, 16, v147
    v_and_b32 v121, 0xffff0000, v148
    v_lshlrev_b32 v120, 16, v148
    v_and_b32 v123, 0xffff0000, v149
    v_lshlrev_b32 v122, 16, v149
    v_and_b32 v125, 0xffff0000, v150
    v_lshlrev_b32 v124, 16, v150
    v_and_b32 v127, 0xffff0000, v151
    v_lshlrev_b32 v126, 16, v151
    v_and_b32 v129, 0xffff0000, v152
    v_lshlrev_b32 v128, 16, v152
    v_and_b32 v131, 0xffff0000, v153
    v_lshlrev_b32 v130, 16, v153
    v_and_b32 v133, 0xffff0000, v154
    v_lshlrev_b32 v132, 16, v154
    v_and_b32 v135, 0xffff0000, v155
    v_lshlrev_b32 v134, 16, v155
    v_sub_f32 v112, v112, v12
    v_sub_f32 v113, v113, v12
    v_sub_f32 v114, v114, v12
    v_sub_f32 v115, v115, v12
    v_sub_f32 v116, v116, v12
    v_sub_f32 v117, v117, v12
    v_sub_f32 v118, v118, v12
    v_sub_f32 v119, v119, v12
    v_sub_f32 v120, v120, v12
    v_sub_f32 v121, v121, v12
    v_sub_f32 v122, v122, v12
    v_sub_f32 v123, v123, v12
    v_sub_f32 v124, v124, v12
    v_sub_f32 v125, v125, v12
    v_sub_f32 v126, v126, v12
    v_sub_f32 v127, v127, v12
    v_sub_f32 v128, v128, v12
    v_sub_f32 v129, v129, v12
    v_sub_f32 v130, v130, v12
    v_sub_f32 v131, v131, v12
    v_sub_f32 v132, v132, v12
    v_sub_f32 v133, v133, v12
    v_sub_f32 v134, v134, v12
    v_sub_f32 v135, v135, v12
    v_cvt_pk_bf16_f32 v2, v112, v113
    v_cvt_pk_bf16_f32 v3, v114, v115
    v_cvt_pk_bf16_f32 v4, v116, v117
    v_cvt_pk_bf16_f32 v5, v118, v119
    v_lshlrev_b32 v112, 16, v2
    v_and_b32 v113, 0xffff0000, v2
    v_lshlrev_b32 v114, 16, v3
    v_and_b32 v115, 0xffff0000, v3
    v_lshlrev_b32 v116, 16, v4
    v_and_b32 v117, 0xffff0000, v4
    v_lshlrev_b32 v118, 16, v5
    v_and_b32 v119, 0xffff0000, v5
    v_cvt_pk_bf16_f32 v2, v120, v121
    v_cvt_pk_bf16_f32 v3, v122, v123
    v_cvt_pk_bf16_f32 v4, v124, v125
    v_cvt_pk_bf16_f32 v5, v126, v127
    v_lshlrev_b32 v120, 16, v2
    v_and_b32 v121, 0xffff0000, v2
    v_lshlrev_b32 v122, 16, v3
    v_and_b32 v123, 0xffff0000, v3
    v_lshlrev_b32 v124, 16, v4
    v_and_b32 v125, 0xffff0000, v4
    v_lshlrev_b32 v126, 16, v5
    v_and_b32 v127, 0xffff0000, v5
    v_cvt_pk_bf16_f32 v2, v128, v129
    v_cvt_pk_bf16_f32 v3, v130, v131
    v_cvt_pk_bf16_f32 v4, v132, v133
    v_cvt_pk_bf16_f32 v5, v134, v135
    v_lshlrev_b32 v128, 16, v2
    v_and_b32 v129, 0xffff0000, v2
    v_lshlrev_b32 v130, 16, v3
    v_and_b32 v131, 0xffff0000, v3
    v_lshlrev_b32 v132, 16, v4
    v_and_b32 v133, 0xffff0000, v4
    v_lshlrev_b32 v134, 16, v5
    v_and_b32 v135, 0xffff0000, v5
    v_mul_f32 v112, v112, v13
    v_mul_f32 v113, v113, v13
    v_mul_f32 v114, v114, v13
    v_mul_f32 v115, v115, v13
    v_mul_f32 v116, v116, v13
    v_mul_f32 v117, v117, v13
    v_mul_f32 v118, v118, v13
    v_mul_f32 v119, v119, v13
    v_mul_f32 v120, v120, v13
    v_mul_f32 v121, v121, v13
    v_mul_f32 v122, v122, v13
    v_mul_f32 v123, v123, v13
    v_mul_f32 v124, v124, v13
    v_mul_f32 v125, v125, v13
    v_mul_f32 v126, v126, v13
    v_mul_f32 v127, v127, v13
    v_mul_f32 v128, v128, v13
    v_mul_f32 v129, v129, v13
    v_mul_f32 v130, v130, v13
    v_mul_f32 v131, v131, v13
    v_mul_f32 v132, v132, v13
    v_mul_f32 v133, v133, v13
    v_mul_f32 v134, v134, v13
    v_mul_f32 v135, v135, v13
    v_cvt_pk_bf16_f32 v2, v112, v113
    v_cvt_pk_bf16_f32 v3, v114, v115
    v_cvt_pk_bf16_f32 v4, v116, v117
    v_cvt_pk_bf16_f32 v5, v118, v119
    v_lshlrev_b32 v112, 16, v2
    v_and_b32 v113, 0xffff0000, v2
    v_lshlrev_b32 v114, 16, v3
    v_and_b32 v115, 0xffff0000, v3
    v_lshlrev_b32 v116, 16, v4
    v_and_b32 v117, 0xffff0000, v4
    v_lshlrev_b32 v118, 16, v5
    v_and_b32 v119, 0xffff0000, v5
    v_cvt_pk_bf16_f32 v2, v120, v121
    v_cvt_pk_bf16_f32 v3, v122, v123
    v_cvt_pk_bf16_f32 v4, v124, v125
    v_cvt_pk_bf16_f32 v5, v126, v127
    v_lshlrev_b32 v120, 16, v2
    v_and_b32 v121, 0xffff0000, v2
    v_lshlrev_b32 v122, 16, v3
    v_and_b32 v123, 0xffff0000, v3
    v_lshlrev_b32 v124, 16, v4
    v_and_b32 v125, 0xffff0000, v4
    v_lshlrev_b32 v126, 16, v5
    v_and_b32 v127, 0xffff0000, v5
    v_cvt_pk_bf16_f32 v2, v128, v129
    v_cvt_pk_bf16_f32 v3, v130, v131
    v_cvt_pk_bf16_f32 v4, v132, v133
    v_cvt_pk_bf16_f32 v5, v134, v135
    v_lshlrev_b32 v128, 16, v2
    v_and_b32 v129, 0xffff0000, v2
    v_lshlrev_b32 v130, 16, v3
    v_and_b32 v131, 0xffff0000, v3
    v_lshlrev_b32 v132, 16, v4
    v_and_b32 v133, 0xffff0000, v4
    v_lshlrev_b32 v134, 16, v5
    v_and_b32 v135, 0xffff0000, v5
    s_waitcnt vmcnt(8)
    v_perm_b32 v2, v20, v16, s78
    v_perm_b32 v20, v20, v16, s79
    v_mov_b32 v16, v2
    v_perm_b32 v2, v28, v24, s78
    v_perm_b32 v3, v28, v24, s79
    v_perm_b32 v24, v21, v17, s78
    v_perm_b32 v28, v21, v17, s79
    v_mov_b32 v17, v2
    v_mov_b32 v21, v3
    v_perm_b32 v2, v36, v32, s78
    v_perm_b32 v3, v36, v32, s79
    v_perm_b32 v32, v22, v18, s78
    v_perm_b32 v36, v22, v18, s79
    v_mov_b32 v18, v2
    v_mov_b32 v22, v3
    v_perm_b32 v2, v44, v40, s78
    v_perm_b32 v3, v44, v40, s79
    v_perm_b32 v40, v23, v19, s78
    v_perm_b32 v44, v23, v19, s79
    v_mov_b32 v19, v2
    v_mov_b32 v23, v3
    v_perm_b32 v2, v29, v25, s78
    v_perm_b32 v29, v29, v25, s79
    v_mov_b32 v25, v2
    v_perm_b32 v2, v37, v33, s78
    v_perm_b32 v3, v37, v33, s79
    v_perm_b32 v33, v30, v26, s78
    v_perm_b32 v37, v30, v26, s79
    v_mov_b32 v26, v2
    v_mov_b32 v30, v3
    v_perm_b32 v2, v45, v41, s78
    v_perm_b32 v3, v45, v41, s79
    v_perm_b32 v41, v31, v27, s78
    v_perm_b32 v45, v31, v27, s79
    v_mov_b32 v27, v2
    v_mov_b32 v31, v3
    v_perm_b32 v2, v38, v34, s78
    v_perm_b32 v38, v38, v34, s79
    v_mov_b32 v34, v2
    v_perm_b32 v2, v46, v42, s78
    v_perm_b32 v3, v46, v42, s79
    v_perm_b32 v42, v39, v35, s78
    v_perm_b32 v46, v39, v35, s79
    v_mov_b32 v35, v2
    v_mov_b32 v39, v3
    v_perm_b32 v2, v47, v43, s78
    v_perm_b32 v47, v47, v43, s79
    v_mov_b32 v43, v2
    s_waitcnt vmcnt(0)
    v_perm_b32 v2, v52, v48, s78
    v_perm_b32 v52, v52, v48, s79
    v_mov_b32 v48, v2
    v_perm_b32 v2, v60, v56, s78
    v_perm_b32 v3, v60, v56, s79
    v_perm_b32 v56, v53, v49, s78
    v_perm_b32 v60, v53, v49, s79
    v_mov_b32 v49, v2
    v_mov_b32 v53, v3
    v_perm_b32 v2, v68, v64, s78
    v_perm_b32 v3, v68, v64, s79
    v_perm_b32 v64, v54, v50, s78
    v_perm_b32 v68, v54, v50, s79
    v_mov_b32 v50, v2
    v_mov_b32 v54, v3
    v_perm_b32 v2, v76, v72, s78
    v_perm_b32 v3, v76, v72, s79
    v_perm_b32 v72, v55, v51, s78
    v_perm_b32 v76, v55, v51, s79
    v_mov_b32 v51, v2
    v_mov_b32 v55, v3
    v_perm_b32 v2, v61, v57, s78
    v_perm_b32 v61, v61, v57, s79
    v_mov_b32 v57, v2
    v_perm_b32 v2, v69, v65, s78
    v_perm_b32 v3, v69, v65, s79
    v_perm_b32 v65, v62, v58, s78
    v_perm_b32 v69, v62, v58, s79
    v_mov_b32 v58, v2
    v_mov_b32 v62, v3
    v_perm_b32 v2, v77, v73, s78
    v_perm_b32 v3, v77, v73, s79
    v_perm_b32 v73, v63, v59, s78
    v_perm_b32 v77, v63, v59, s79
    v_mov_b32 v59, v2
    v_mov_b32 v63, v3
    v_perm_b32 v2, v70, v66, s78
    v_perm_b32 v70, v70, v66, s79
    v_mov_b32 v66, v2
    v_perm_b32 v2, v78, v74, s78
    v_perm_b32 v3, v78, v74, s79
    v_perm_b32 v74, v71, v67, s78
    v_perm_b32 v78, v71, v67, s79
    v_mov_b32 v67, v2
    v_mov_b32 v71, v3
    v_perm_b32 v2, v79, v75, s78
    v_perm_b32 v79, v79, v75, s79
    v_mov_b32 v75, v2
    s_cmp_lg_u32 s3, 0
    s_cbranch_scc1 HT_2
    v_perm_b32 v2, v84, v80, s78
    v_perm_b32 v84, v84, v80, s79
    v_mov_b32 v80, v2
    v_perm_b32 v2, v92, v88, s78
    v_perm_b32 v3, v92, v88, s79
    v_perm_b32 v88, v85, v81, s78
    v_perm_b32 v92, v85, v81, s79
    v_mov_b32 v81, v2
    v_mov_b32 v85, v3
    v_perm_b32 v2, v100, v96, s78
    v_perm_b32 v3, v100, v96, s79
    v_perm_b32 v96, v86, v82, s78
    v_perm_b32 v100, v86, v82, s79
    v_mov_b32 v82, v2
    v_mov_b32 v86, v3
    v_perm_b32 v2, v108, v104, s78
    v_perm_b32 v3, v108, v104, s79
    v_perm_b32 v104, v87, v83, s78
    v_perm_b32 v108, v87, v83, s79
    v_mov_b32 v83, v2
    v_mov_b32 v87, v3
    v_perm_b32 v2, v93, v89, s78
    v_perm_b32 v93, v93, v89, s79
    v_mov_b32 v89, v2
    v_perm_b32 v2, v101, v97, s78
    v_perm_b32 v3, v101, v97, s79
    v_perm_b32 v97, v94, v90, s78
    v_perm_b32 v101, v94, v90, s79
    v_mov_b32 v90, v2
    v_mov_b32 v94, v3
    v_perm_b32 v2, v109, v105, s78
    v_perm_b32 v3, v109, v105, s79
    v_perm_b32 v105, v95, v91, s78
    v_perm_b32 v109, v95, v91, s79
    v_mov_b32 v91, v2
    v_mov_b32 v95, v3
    v_perm_b32 v2, v102, v98, s78
    v_perm_b32 v102, v102, v98, s79
    v_mov_b32 v98, v2
    v_perm_b32 v2, v110, v106, s78
    v_perm_b32 v3, v110, v106, s79
    v_perm_b32 v106, v103, v99, s78
    v_perm_b32 v110, v103, v99, s79
    v_mov_b32 v99, v2
    v_mov_b32 v103, v3
    v_perm_b32 v2, v111, v107, s78
    v_perm_b32 v111, v111, v107, s79
    v_mov_b32 v107, v2
HT_2:
    s_cmp_lg_u32 s3, 3
    s_cbranch_scc1 L_q_nopz
    v_mov_b32 v10, s32
    v_mov_b32 v11, s33
    s_lshl_b32 s35, s2, 4
    s_add_u32 s35, s35, 376832
    s_branch L_q_pzgo
    s_mov_b32 s80, 0
SP_3:
    ds_read_b32 v2, v0 offset:32
    s_waitcnt lgkmcnt(0)
    v_readfirstlane_b32 s81, v2
    s_cmp_ge_u32 s81, 1
    s_nop 2
    s_cbranch_scc1 SPD_4
    s_add_u32 s80, s80, 1
    s_cmp_gt_u32 s80, 100000
    s_cbranch_scc1 SPD_4
    s_sleep 4
    s_branch SP_3
SPD_4:
L_q_pzgo:
    s_waitcnt vmcnt(0)
    s_mov_b64 exec, 1
    buffer_store_dwordx2 v[10:11], v0, s[12:15], s35 offen sc1
    s_mov_b64 exec, -1
    s_waitcnt lgkmcnt(0)
    v_mov_b32 v2, 1
    s_mov_b64 exec, 1
    ds_add_u32 v0, v2 offset:0
    s_mov_b64 exec, -1
L_q_nopz:
    v_lshlrev_b32 v4, 4, v1
    v_lshrrev_b32 v5, 5, v1
    v_mul_u32_u24 v5, 4096, v5
    v_add_u32 v5, v5, v4
    s_lshl_b32 s72, s74, 2
    s_add_u32 s72, s72, 0
    s_add_u32 s73, s72, 4608
    s_mov_b32 s76, 1024
    v_and_b32 v6, 1, v1
    v_lshlrev_b32 v6, 4, v6
    v_sub_u32 v6, 16, v6
    s_lshl_b32 s75, s3, 10
    s_add_u32 s75, s75, 18432
    v_lshlrev_b32 v7, 3, v1
    v_add_u32 v8, s75, v7
    v_lshlrev_b32 v10, 5, v14
    v_add_u32 v9, s75, v10
    s_cmp_eq_u32 s3, 0
    s_cbranch_scc1 L_hq_x
    s_mov_b32 s80, 0
TP_5:
    buffer_load_dwordx4 v[156:159], v4, s[12:15], s72 offen offset:0 sc1
    buffer_load_dwordx4 v[160:163], v4, s[12:15], s73 offen offset:0 sc1
    s_waitcnt vmcnt(0)
    v_cmp_ne_u64 s[66:67], s[32:33], v[158:159]
    v_cmp_ne_u64 vcc, s[32:33], v[162:163]
    s_or_b64 s[66:67], s[66:67], vcc
    s_cmp_eq_u64 s[66:67], 0
    s_nop 1
    s_cbranch_scc1 TPD_6
    s_add_u32 s80, s80, 1
    s_cmp_gt_u32 s80, 100000
    s_cbranch_scc1 TPD_6
    s_sleep 2
    s_branch TP_5
TPD_6:
    s_branch L_hq_j
L_hq_x:
    s_mov_b32 s80, 0
TP_7:
    buffer_load_dwordx4 v[156:159], v4, s[12:15], s72 offen offset:0 sc1
    buffer_load_dwordx4 v[160:163], v4, s[12:15], s73 offen offset:0 sc1
    buffer_load_dwordx4 v[164:167], v5, s[12:15], s76 offen offset:0 sc1
    s_waitcnt vmcnt(0)
    v_cmp_ne_u64 s[66:67], s[32:33], v[158:159]
    v_cmp_ne_u64 vcc, s[32:33], v[162:163]
    s_or_b64 s[66:67], s[66:67], vcc
    v_cmp_ne_u64 vcc, s[32:33], v[166:167]
    s_or_b64 s[66:67], s[66:67], vcc
    s_cmp_eq_u64 s[66:67], 0
    s_nop 1
    s_cbranch_scc1 TPD_8
    s_add_u32 s80, s80, 1
    s_cmp_gt_u32 s80, 100000
    s_cbranch_scc1 TPD_8
    s_sleep 2
    s_branch TP_7
TPD_8:
    ds_write_b64 v7, v[164:165] offset:23040
L_hq_j:
    ds_write_b64 v8, v[156:157]
    ds_write_b64 v8, v[160:161] offset:512
    s_waitcnt lgkmcnt(0)
    ds_read_b128 v[156:159], v9 offset:512
    ds_read_b128 v[160:163], v9 offset:528
    ds_read_b128 v[136:139], v9 offset:0
    ds_read_b128 v[140:143], v9 offset:16
    s_waitcnt lgkmcnt(2)
    v_lshlrev_b32 v156, v6, v156
    v_lshlrev_b32 v157, v6, v157
    v_lshlrev_b32 v158, v6, v158
    v_lshlrev_b32 v159, v6, v159
    v_lshlrev_b32 v160, v6, v160
    v_lshlrev_b32 v161, v6, v161
    v_lshlrev_b32 v162, v6, v162
    v_lshlrev_b32 v163, v6, v163
    v_and_b32 v156, 0xffff0000, v156
    v_and_b32 v157, 0xffff0000, v157
    v_and_b32 v158, 0xffff0000, v158
    v_and_b32 v159, 0xffff0000, v159
    v_and_b32 v160, 0xffff0000, v160
    v_and_b32 v161, 0xffff0000, v161
    v_and_b32 v162, 0xffff0000, v162
    v_and_b32 v163, 0xffff0000, v163
    v_add_f32 v156, 1.0, v156
    v_add_f32 v157, 1.0, v157
    v_add_f32 v158, 1.0, v158
    v_add_f32 v159, 1.0, v159
    v_add_f32 v160, 1.0, v160
    v_add_f32 v161, 1.0, v161
    v_add_f32 v162, 1.0, v162
    v_add_f32 v163, 1.0, v163
    v_cvt_pk_bf16_f32 v2, v156, v157
    v_cvt_pk_bf16_f32 v3, v158, v159
    v_cvt_pk_bf16_f32 v4, v160, v161
    v_cvt_pk_bf16_f32 v5, v162, v163
    v_lshlrev_b32 v156, 16, v2
    v_and_b32 v157, 0xffff0000, v2
    v_lshlrev_b32 v158, 16, v3
    v_and_b32 v159, 0xffff0000, v3
    v_lshlrev_b32 v160, 16, v4
    v_and_b32 v161, 0xffff0000, v4
    v_lshlrev_b32 v162, 16, v5
    v_and_b32 v163, 0xffff0000, v5
    v_pk_mul_f32 v[112:113], v[112:113], v[156:157]
    v_pk_mul_f32 v[114:115], v[114:115], v[158:159]
    v_pk_mul_f32 v[116:117], v[116:117], v[160:161]
    v_pk_mul_f32 v[118:119], v[118:119], v[162:163]
    v_cvt_pk_bf16_f32 v2, v112, v113
    v_cvt_pk_bf16_f32 v3, v114, v115
    v_cvt_pk_bf16_f32 v4, v116, v117
    v_cvt_pk_bf16_f32 v5, v118, v119
    v_lshlrev_b32 v112, 16, v2
    v_and_b32 v113, 0xffff0000, v2
    v_lshlrev_b32 v114, 16, v3
    v_and_b32 v115, 0xffff0000, v3
    v_lshlrev_b32 v116, 16, v4
    v_and_b32 v117, 0xffff0000, v4
    v_lshlrev_b32 v118, 16, v5
    v_and_b32 v119, 0xffff0000, v5
    s_waitcnt lgkmcnt(0)
    v_lshlrev_b32 v136, v6, v136
    v_lshlrev_b32 v137, v6, v137
    v_lshlrev_b32 v138, v6, v138
    v_lshlrev_b32 v139, v6, v139
    v_lshlrev_b32 v140, v6, v140
    v_lshlrev_b32 v141, v6, v141
    v_lshlrev_b32 v142, v6, v142
    v_lshlrev_b32 v143, v6, v143
    v_and_b32 v136, 0xffff0000, v136
    v_and_b32 v137, 0xffff0000, v137
    v_and_b32 v138, 0xffff0000, v138
    v_and_b32 v139, 0xffff0000, v139
    v_and_b32 v140, 0xffff0000, v140
    v_and_b32 v141, 0xffff0000, v141
    v_and_b32 v142, 0xffff0000, v142
    v_and_b32 v143, 0xffff0000, v143
    v_pk_add_f32 v[112:113], v[112:113], v[136:137]
    v_pk_add_f32 v[114:115], v[114:115], v[138:139]
    v_pk_add_f32 v[116:117], v[116:117], v[140:141]
    v_pk_add_f32 v[118:119], v[118:119], v[142:143]
    v_cvt_pk_bf16_f32 v144, v112, v113
    v_cvt_pk_bf16_f32 v145, v114, v115
    v_cvt_pk_bf16_f32 v146, v116, v117
    v_cvt_pk_bf16_f32 v147, v118, v119
    ds_read_b128 v[156:159], v9 offset:768
    ds_read_b128 v[160:163], v9 offset:784
    ds_read_b128 v[136:139], v9 offset:256
    ds_read_b128 v[140:143], v9 offset:272
    s_waitcnt lgkmcnt(2)
    v_lshlrev_b32 v156, v6, v156
    v_lshlrev_b32 v157, v6, v157
    v_lshlrev_b32 v158, v6, v158
    v_lshlrev_b32 v159, v6, v159
    v_lshlrev_b32 v160, v6, v160
    v_lshlrev_b32 v161, v6, v161
    v_lshlrev_b32 v162, v6, v162
    v_lshlrev_b32 v163, v6, v163
    v_and_b32 v156, 0xffff0000, v156
    v_and_b32 v157, 0xffff0000, v157
    v_and_b32 v158, 0xffff0000, v158
    v_and_b32 v159, 0xffff0000, v159
    v_and_b32 v160, 0xffff0000, v160
    v_and_b32 v161, 0xffff0000, v161
    v_and_b32 v162, 0xffff0000, v162
    v_and_b32 v163, 0xffff0000, v163
    v_add_f32 v156, 1.0, v156
    v_add_f32 v157, 1.0, v157
    v_add_f32 v158, 1.0, v158
    v_add_f32 v159, 1.0, v159
    v_add_f32 v160, 1.0, v160
    v_add_f32 v161, 1.0, v161
    v_add_f32 v162, 1.0, v162
    v_add_f32 v163, 1.0, v163
    v_cvt_pk_bf16_f32 v2, v156, v157
    v_cvt_pk_bf16_f32 v3, v158, v159
    v_cvt_pk_bf16_f32 v4, v160, v161
    v_cvt_pk_bf16_f32 v5, v162, v163
    v_lshlrev_b32 v156, 16, v2
    v_and_b32 v157, 0xffff0000, v2
    v_lshlrev_b32 v158, 16, v3
    v_and_b32 v159, 0xffff0000, v3
    v_lshlrev_b32 v160, 16, v4
    v_and_b32 v161, 0xffff0000, v4
    v_lshlrev_b32 v162, 16, v5
    v_and_b32 v163, 0xffff0000, v5
    v_pk_mul_f32 v[120:121], v[120:121], v[156:157]
    v_pk_mul_f32 v[122:123], v[122:123], v[158:159]
    v_pk_mul_f32 v[124:125], v[124:125], v[160:161]
    v_pk_mul_f32 v[126:127], v[126:127], v[162:163]
    v_cvt_pk_bf16_f32 v2, v120, v121
    v_cvt_pk_bf16_f32 v3, v122, v123
    v_cvt_pk_bf16_f32 v4, v124, v125
    v_cvt_pk_bf16_f32 v5, v126, v127
    v_lshlrev_b32 v120, 16, v2
    v_and_b32 v121, 0xffff0000, v2
    v_lshlrev_b32 v122, 16, v3
    v_and_b32 v123, 0xffff0000, v3
    v_lshlrev_b32 v124, 16, v4
    v_and_b32 v125, 0xffff0000, v4
    v_lshlrev_b32 v126, 16, v5
    v_and_b32 v127, 0xffff0000, v5
    s_waitcnt lgkmcnt(0)
    v_lshlrev_b32 v136, v6, v136
    v_lshlrev_b32 v137, v6, v137
    v_lshlrev_b32 v138, v6, v138
    v_lshlrev_b32 v139, v6, v139
    v_lshlrev_b32 v140, v6, v140
    v_lshlrev_b32 v141, v6, v141
    v_lshlrev_b32 v142, v6, v142
    v_lshlrev_b32 v143, v6, v143
    v_and_b32 v136, 0xffff0000, v136
    v_and_b32 v137, 0xffff0000, v137
    v_and_b32 v138, 0xffff0000, v138
    v_and_b32 v139, 0xffff0000, v139
    v_and_b32 v140, 0xffff0000, v140
    v_and_b32 v141, 0xffff0000, v141
    v_and_b32 v142, 0xffff0000, v142
    v_and_b32 v143, 0xffff0000, v143
    v_pk_add_f32 v[120:121], v[120:121], v[136:137]
    v_pk_add_f32 v[122:123], v[122:123], v[138:139]
    v_pk_add_f32 v[124:125], v[124:125], v[140:141]
    v_pk_add_f32 v[126:127], v[126:127], v[142:143]
    v_cvt_pk_bf16_f32 v148, v120, v121
    v_cvt_pk_bf16_f32 v149, v122, v123
    v_cvt_pk_bf16_f32 v150, v124, v125
    v_cvt_pk_bf16_f32 v151, v126, v127
    s_cmp_lg_u32 s3, 0
    s_cbranch_scc1 L_hgemv
    ds_read_b128 v[156:159], v10 offset:23296
    ds_read_b128 v[160:163], v10 offset:23312
    ds_read_b128 v[136:139], v10 offset:23040
    ds_read_b128 v[140:143], v10 offset:23056
    s_waitcnt lgkmcnt(2)
    v_lshlrev_b32 v156, v6, v156
    v_lshlrev_b32 v157, v6, v157
    v_lshlrev_b32 v158, v6, v158
    v_lshlrev_b32 v159, v6, v159
    v_lshlrev_b32 v160, v6, v160
    v_lshlrev_b32 v161, v6, v161
    v_lshlrev_b32 v162, v6, v162
    v_lshlrev_b32 v163, v6, v163
    v_and_b32 v156, 0xffff0000, v156
    v_and_b32 v157, 0xffff0000, v157
    v_and_b32 v158, 0xffff0000, v158
    v_and_b32 v159, 0xffff0000, v159
    v_and_b32 v160, 0xffff0000, v160
    v_and_b32 v161, 0xffff0000, v161
    v_and_b32 v162, 0xffff0000, v162
    v_and_b32 v163, 0xffff0000, v163
    v_add_f32 v156, 1.0, v156
    v_add_f32 v157, 1.0, v157
    v_add_f32 v158, 1.0, v158
    v_add_f32 v159, 1.0, v159
    v_add_f32 v160, 1.0, v160
    v_add_f32 v161, 1.0, v161
    v_add_f32 v162, 1.0, v162
    v_add_f32 v163, 1.0, v163
    v_cvt_pk_bf16_f32 v2, v156, v157
    v_cvt_pk_bf16_f32 v3, v158, v159
    v_cvt_pk_bf16_f32 v4, v160, v161
    v_cvt_pk_bf16_f32 v5, v162, v163
    v_lshlrev_b32 v156, 16, v2
    v_and_b32 v157, 0xffff0000, v2
    v_lshlrev_b32 v158, 16, v3
    v_and_b32 v159, 0xffff0000, v3
    v_lshlrev_b32 v160, 16, v4
    v_and_b32 v161, 0xffff0000, v4
    v_lshlrev_b32 v162, 16, v5
    v_and_b32 v163, 0xffff0000, v5
    v_pk_mul_f32 v[128:129], v[128:129], v[156:157]
    v_pk_mul_f32 v[130:131], v[130:131], v[158:159]
    v_pk_mul_f32 v[132:133], v[132:133], v[160:161]
    v_pk_mul_f32 v[134:135], v[134:135], v[162:163]
    v_cvt_pk_bf16_f32 v2, v128, v129
    v_cvt_pk_bf16_f32 v3, v130, v131
    v_cvt_pk_bf16_f32 v4, v132, v133
    v_cvt_pk_bf16_f32 v5, v134, v135
    v_lshlrev_b32 v128, 16, v2
    v_and_b32 v129, 0xffff0000, v2
    v_lshlrev_b32 v130, 16, v3
    v_and_b32 v131, 0xffff0000, v3
    v_lshlrev_b32 v132, 16, v4
    v_and_b32 v133, 0xffff0000, v4
    v_lshlrev_b32 v134, 16, v5
    v_and_b32 v135, 0xffff0000, v5
    s_waitcnt lgkmcnt(0)
    v_lshlrev_b32 v136, v6, v136
    v_lshlrev_b32 v137, v6, v137
    v_lshlrev_b32 v138, v6, v138
    v_lshlrev_b32 v139, v6, v139
    v_lshlrev_b32 v140, v6, v140
    v_lshlrev_b32 v141, v6, v141
    v_lshlrev_b32 v142, v6, v142
    v_lshlrev_b32 v143, v6, v143
    v_and_b32 v136, 0xffff0000, v136
    v_and_b32 v137, 0xffff0000, v137
    v_and_b32 v138, 0xffff0000, v138
    v_and_b32 v139, 0xffff0000, v139
    v_and_b32 v140, 0xffff0000, v140
    v_and_b32 v141, 0xffff0000, v141
    v_and_b32 v142, 0xffff0000, v142
    v_and_b32 v143, 0xffff0000, v143
    v_pk_add_f32 v[128:129], v[128:129], v[136:137]
    v_pk_add_f32 v[130:131], v[130:131], v[138:139]
    v_pk_add_f32 v[132:133], v[132:133], v[140:141]
    v_pk_add_f32 v[134:135], v[134:135], v[142:143]
    v_cvt_pk_bf16_f32 v152, v128, v129
    v_cvt_pk_bf16_f32 v153, v130, v131
    v_cvt_pk_bf16_f32 v154, v132, v133
    v_cvt_pk_bf16_f32 v155, v134, v135
    s_nop 0
    s_branch L_hgemv
L_nohead0:
    buffer_load_dwordx2 v[12:13], v0, s[12:15], s76 offen sc1
    s_barrier
    s_sub_u32 s72, s2, 160
    s_cmp_ge_u32 s72, 16
    s_cbranch_scc1 L_nopf
    s_getpc_b64 s[72:73]
L_pc:
    s_sub_u32 s72, s72, L_pc-adaLN_cond__gqa_block_cached__dense_activation_squared_relu__decode_kernel
    s_subb_u32 s73, s73, 0
    v_lshlrev_b32 v2, 4, v1
    s_lshl_b32 s74, s3, 10
    v_add_u32 v2, s74, v2
    v_cmp_gt_u32 vcc, 28401, v2
    s_and_saveexec_b64 s[66:67], vcc
    s_nop 2
    s_cbranch_execz L_pf0
    global_load_dwordx4 v[16:19], v2, s[72:73]
L_pf0:
    s_mov_b64 exec, -1
    s_add_u32 s72, s72, 4096
    s_addc_u32 s73, s73, 0
    v_cmp_gt_u32 vcc, 24305, v2
    s_and_saveexec_b64 s[66:67], vcc
    s_nop 2
    s_cbranch_execz L_pf1
    global_load_dwordx4 v[20:23], v2, s[72:73]
L_pf1:
    s_mov_b64 exec, -1
    s_add_u32 s72, s72, 4096
    s_addc_u32 s73, s73, 0
    v_cmp_gt_u32 vcc, 20209, v2
    s_and_saveexec_b64 s[66:67], vcc
    s_nop 2
    s_cbranch_execz L_pf2
    global_load_dwordx4 v[24:27], v2, s[72:73]
L_pf2:
    s_mov_b64 exec, -1
    s_add_u32 s72, s72, 4096
    s_addc_u32 s73, s73, 0
    v_cmp_gt_u32 vcc, 16113, v2
    s_and_saveexec_b64 s[66:67], vcc
    s_nop 2
    s_cbranch_execz L_pf3
    global_load_dwordx4 v[28:31], v2, s[72:73]
L_pf3:
    s_mov_b64 exec, -1
    s_add_u32 s72, s72, 4096
    s_addc_u32 s73, s73, 0
    v_cmp_gt_u32 vcc, 12017, v2
    s_and_saveexec_b64 s[66:67], vcc
    s_nop 2
    s_cbranch_execz L_pf4
    global_load_dwordx4 v[32:35], v2, s[72:73]
L_pf4:
    s_mov_b64 exec, -1
    s_add_u32 s72, s72, 4096
    s_addc_u32 s73, s73, 0
    v_cmp_gt_u32 vcc, 7921, v2
    s_and_saveexec_b64 s[66:67], vcc
    s_nop 2
    s_cbranch_execz L_pf5
    global_load_dwordx4 v[36:39], v2, s[72:73]
L_pf5:
    s_mov_b64 exec, -1
    s_add_u32 s72, s72, 4096
    s_addc_u32 s73, s73, 0
    v_cmp_gt_u32 vcc, 3825, v2
    s_and_saveexec_b64 s[66:67], vcc
    s_nop 2
    s_cbranch_execz L_pf6
    global_load_dwordx4 v[40:43], v2, s[72:73]
L_pf6:
    s_mov_b64 exec, -1
    s_add_u32 s72, s72, 4096
    s_addc_u32 s73, s73, 0
L_nopf:
    s_waitcnt vmcnt(0)
    v_readfirstlane_b32 s32, v12
    v_readfirstlane_b32 s33, v13
    s_add_u32 s32, s32, 1
    s_addc_u32 s33, s33, 0
L_head_done:
    s_cmp_lg_u32 s3, 0
    s_nop 0
    s_cbranch_scc1 L_c_noq
    v_lshlrev_b32 v4, 4, v1
    v_lshlrev_b32 v5, 3, v1
    s_and_b32 s72, s2, 31
    s_lshl_b32 s72, s72, 10
    s_add_u32 s72, s72, 32768
    s_mov_b32 s80, 0
    buffer_load_dwordx4 v[48:51], v4, s[12:15], s72 offen sc1
    s_sleep 16
    buffer_load_dwordx4 v[52:55], v4, s[12:15], s72 offen sc1
    s_sleep 16
    buffer_load_dwordx4 v[56:59], v4, s[12:15], s72 offen sc1
PP_9:
    s_waitcnt vmcnt(2)
    v_cmp_ne_u64 vcc, s[32:33], v[50:51]
    s_nop 3
    s_cbranch_vccz PPD_10
    s_sleep 2
    buffer_load_dwordx4 v[48:51], v4, s[12:15], s72 offen sc1
    s_waitcnt vmcnt(2)
    v_cmp_ne_u64 vcc, s[32:33], v[54:55]
    s_nop 3
    s_cbranch_vccz PPD_11
    s_sleep 2
    buffer_load_dwordx4 v[52:55], v4, s[12:15], s72 offen sc1
    s_waitcnt vmcnt(2)
    v_cmp_ne_u64 vcc, s[32:33], v[58:59]
    s_nop 3
    s_cbranch_vccz PPD_12
    s_sleep 2
    buffer_load_dwordx4 v[56:59], v4, s[12:15], s72 offen sc1
    s_add_u32 s80, s80, 1
    s_cmp_gt_u32 s80, 100000
    s_cbranch_scc0 PP_9
PPD_10:
    v_mov_b32 v6, v48
    v_mov_b32 v7, v49
    s_nop 0
    s_branch PPE_13
PPD_11:
    v_mov_b32 v6, v52
    v_mov_b32 v7, v53
    s_nop 0
    s_branch PPE_13
PPD_12:
    v_mov_b32 v6, v56
    v_mov_b32 v7, v57
PPE_13:
    s_setprio 3
    ds_write_b64 v5, v[6:7] offset:512
    s_waitcnt lgkmcnt(0)
    v_mov_b32 v2, 1
    s_mov_b64 exec, 1
    ds_add_u32 v0, v2 offset:8
    s_mov_b64 exec, -1
L_c_noq:
    s_cmp_eq_u32 s83, 1
    s_cbranch_scc1 L_c_nopz
    s_cmp_lg_u32 s3, 3
    s_cbranch_scc1 L_c_nopz
    v_mov_b32 v10, s32
    v_mov_b32 v11, s33
    s_lshl_b32 s35, s2, 4
    s_add_u32 s35, s35, 376832
    s_cmp_lg_u32 s83, 2
    s_cbranch_scc1 L_pz_go
    s_bitcmp1_b32 s100, 30
    s_cbranch_scc1 L_pz_go
    s_mov_b32 s80, 0
SP_14:
    ds_read_b32 v2, v0 offset:32
    s_waitcnt lgkmcnt(0)
    v_readfirstlane_b32 s81, v2
    s_cmp_ge_u32 s81, 1
    s_nop 2
    s_cbranch_scc1 SPD_15
    s_add_u32 s80, s80, 1
    s_cmp_gt_u32 s80, 100000
    s_cbranch_scc1 SPD_15
    s_sleep 4
    s_branch SP_14
SPD_15:
L_pz_go:
    s_waitcnt vmcnt(0)
    s_mov_b64 exec, 1
    buffer_store_dwordx2 v[10:11], v0, s[12:15], s35 offen sc1
    s_mov_b64 exec, -1
    s_waitcnt lgkmcnt(0)
    v_mov_b32 v2, 1
    s_mov_b64 exec, 1
    ds_add_u32 v0, v2 offset:0
    s_mov_b64 exec, -1
L_c_nopz:
    s_cmp_lg_u32 s3, 1
    s_cbranch_scc1 L_c_noarr
    s_mov_b32 s80, 0
SP_16:
    ds_read_b32 v2, v0 offset:8
    s_waitcnt lgkmcnt(0)
    v_readfirstlane_b32 s81, v2
    s_cmp_ge_u32 s81, 1
    s_nop 2
    s_cbranch_scc1 SPD_17
    s_add_u32 s80, s80, 1
    s_cmp_gt_u32 s80, 100000
    s_cbranch_scc1 SPD_17
    s_sleep 8
    s_branch SP_16
SPD_17:
    s_mov_b32 s80, 0
    v_lshlrev_b32 v2, 4, v1
    s_mov_b32 s72, 376832
AR_18:
    buffer_load_dwordx2 v[48:49], v2, s[12:15], s72 offen offset:0 sc1
    buffer_load_dwordx2 v[50:51], v2, s[12:15], s72 offen offset:1024 sc1
    buffer_load_dwordx2 v[52:53], v2, s[12:15], s72 offen offset:2048 sc1
    buffer_load_dwordx2 v[54:55], v2, s[12:15], s72 offen offset:3072 sc1
    s_waitcnt vmcnt(0)
    v_cmp_ne_u64 s[66:67], s[32:33], v[48:49]
    v_cmp_ne_u64 vcc, s[32:33], v[50:51]
    s_or_b64 s[66:67], s[66:67], vcc
    v_cmp_ne_u64 vcc, s[32:33], v[52:53]
    s_or_b64 s[66:67], s[66:67], vcc
    v_cmp_ne_u64 vcc, s[32:33], v[54:55]
    s_or_b64 s[66:67], s[66:67], vcc
    s_nop 2
    s_cbranch_scc0 ARD_19
    s_add_u32 s80, s80, 1
    s_cmp_gt_u32 s80, 100000
    s_cbranch_scc1 ARD_19
    s_sleep 32
    s_branch AR_18
ARD_19:
    s_waitcnt lgkmcnt(0)
    v_mov_b32 v2, 1
    s_mov_b64 exec, 1
    ds_add_u32 v0, v2 offset:36
    s_mov_b64 exec, -1
L_c_noarr:
    s_cmp_lg_u32 s3, 0
    s_cbranch_scc1 L_c_mid
    s_and_b32 s72, s2, 31
    s_lshl_b32 s72, s72, 8
    s_lshr_b32 s73, s2, 5
    s_lshl_b32 s73, s73, 5
    s_add_u32 s73, s73, s72
    s_add_u32 s73, s73, 368640
    v_and_b32 v5, 8, v1
    v_lshlrev_b32 v3, 1, v5
    v_mov_b32 v10, s32
    v_mov_b32 v11, s33
    v_and_b32 v12, 15, v1
    v_lshlrev_b32 v12, 2, v12
    s_mov_b32 s80, 0
SP_20:
    ds_read_b32 v2, v0 offset:48
    s_waitcnt lgkmcnt(0)
    v_readfirstlane_b32 s81, v2
    s_cmp_ge_u32 s81, 8
    s_nop 2
    s_cbranch_scc1 SPD_21
    s_add_u32 s80, s80, 1
    s_cmp_gt_u32 s80, 100000
    s_cbranch_scc1 SPD_21
    s_sleep 4
    s_branch SP_20
SPD_21:
    ds_read_b32 v8, v12 offset:128
    ds_read_b32 v9, v12 offset:192
    s_waitcnt lgkmcnt(0)
    v_max_f32_dpp v8, v8, v8 quad_perm:[1,0,3,2] row_mask:0xf bank_mask:0xf
    v_add_f32_dpp v9, v9, v9 quad_perm:[1,0,3,2] row_mask:0xf bank_mask:0xf
    s_nop 0
    v_max_f32_dpp v8, v8, v8 quad_perm:[2,3,0,1] row_mask:0xf bank_mask:0xf
    v_add_f32_dpp v9, v9, v9 quad_perm:[2,3,0,1] row_mask:0xf bank_mask:0xf
    s_nop 0
    v_max_f32_dpp v8, v8, v8 row_half_mirror row_mask:0xf bank_mask:0xf
    v_add_f32_dpp v9, v9, v9 row_half_mirror row_mask:0xf bank_mask:0xf
    s_mov_b64 exec, 0x101
    buffer_store_dwordx4 v[8:11], v3, s[12:15], s73 offen sc1
    s_mov_b64 exec, -1
    s_waitcnt vmcnt(0)
L_c_mid:
    s_cmp_eq_u32 s69, 0
    s_cbranch_scc1 L_t_none
    s_cmp_eq_u32 s69, 2
    s_cbranch_scc1 L_t_o
    s_branch L_fw1
L_fw0r:
    s_mov_b32 s16, s48
    s_and_b32 s17, s49, 0xffff
    s_mov_b32 s18, 5308416
    s_mov_b32 s19, 0x00020000
    s_bitcmp0_b32 s100, 31
    s_cbranch_scc1 L_f_w1e
    s_mov_b32 s80, 0
SP_22:
    ds_read_b32 v2, v0 offset:44
    s_waitcnt lgkmcnt(0)
    v_readfirstlane_b32 s81, v2
    s_cmp_ge_u32 s81, 8
    s_nop 2
    s_cbranch_scc1 SPD_23
    s_add_u32 s80, s80, 1
    s_cmp_gt_u32 s80, 100000
    s_cbranch_scc1 SPD_23
    s_sleep 8
    s_branch SP_22
SPD_23:
    s_mov_b32 s70, 9216
    v_lshrrev_b32 v2, 2, v1
    v_and_b32 v8, 3, v1
    v_lshlrev_b32 v8, 4, v8
    v_mul_u32_u24 v3, 9216, v2
    v_lshl_add_u32 v4, v3, 3, v8
    v_lshl_add_u32 v5, v3, 2, v8
    s_lshl_b32 s72, s101, 6
    s_mul_i32 s73, s3, 1179648
    s_add_u32 s73, s73, s72
    buffer_load_dwordx4 v[16:19], v4, s[16:19], s73 offen nt
    s_add_u32 s73, s73, s70
    buffer_load_dwordx4 v[20:23], v4, s[16:19], s73 offen nt
    s_add_u32 s73, s73, s70
    buffer_load_dwordx4 v[24:27], v4, s[16:19], s73 offen nt
    s_add_u32 s73, s73, s70
    buffer_load_dwordx4 v[28:31], v4, s[16:19], s73 offen nt
    s_add_u32 s73, s73, s70
    buffer_load_dwordx4 v[32:35], v4, s[16:19], s73 offen nt
    s_add_u32 s73, s73, s70
    buffer_load_dwordx4 v[36:39], v4, s[16:19], s73 offen nt
    s_add_u32 s73, s73, s70
    buffer_load_dwordx4 v[40:43], v4, s[16:19], s73 offen nt
    s_add_u32 s73, s73, s70
    buffer_load_dwordx4 v[44:47], v4, s[16:19], s73 offen nt
    s_cmp_lg_u32 s3, 3
    s_cbranch_scc1 NX_24
    s_lshl_b32 s73, s70, 9
    s_add_u32 s73, s73, s72
    buffer_load_dwordx4 v[80:83], v5, s[16:19], s73 offen nt
    s_add_u32 s73, s73, s70
    buffer_load_dwordx4 v[84:87], v5, s[16:19], s73 offen nt
    s_add_u32 s73, s73, s70
    buffer_load_dwordx4 v[88:91], v5, s[16:19], s73 offen nt
    s_add_u32 s73, s73, s70
    buffer_load_dwordx4 v[92:95], v5, s[16:19], s73 offen nt
NX_24:
L_f_w1e:
    s_mov_b32 s28, s36
    s_and_b32 s29, s37, 0xffff
    s_mov_b32 s30, 2304
    s_mov_b32 s31, 0x00020000
    s_mov_b32 s20, s50
    s_and_b32 s21, s51, 0xffff
    s_mov_b32 s22, 9216
    s_mov_b32 s23, 0x00020000
    s_mov_b32 s24, s54
    s_and_b32 s25, s55, 0xffff
    s_mov_b32 s26, 1152
    s_mov_b32 s27, 0x00020000
    s_min_u32 s77, s101, 35
    s_cmp_ge_u32 s77, 18
    s_cselect_b32 s76, 1, 0
    s_mul_i32 s72, s76, 18
    s_sub_u32 s77, s77, s72
    s_cmp_eq_u32 s3, 3
    s_cselect_b32 s66, 24, 16
    s_cselect_b32 s67, 12, 8
    v_and_b32 v3, 31, v1
    v_mul_u32_u24 v4, s66, v3
    v_lshrrev_b32 v6, 5, v1
    v_mul_u32_u24 v6, 1152, v6
    v_mad_u32_u24 v7, s67, v3, v6
    s_lshl_b32 s71, s3, 8
    v_lshrrev_b32 v2, 1, v1
    v_lshlrev_b32 v2, 1, v2
    v_lshlrev_b32 v9, 1, v3
    v_lshlrev_b32 v8, 2, v3
    s_lshl_b32 s70, s77, 7
    s_add_u32 s70, s70, 23296
    s_lshl_b32 s72, s3, 9
    s_add_u32 s72, s72, 16384
    s_add_u32 s73, s72, 4608
    s_lshl_b32 s4, s101, 6
    s_lshl_b32 s5, s77, 6
    s_mov_b32 s80, 0
SP_25:
    ds_read_b32 v3, v0 offset:36
    s_waitcnt lgkmcnt(0)
    v_readfirstlane_b32 s81, v3
    s_cmp_ge_u32 s81, 1
    s_nop 2
    s_cbranch_scc1 SPD_26
    s_add_u32 s80, s80, 1
    s_cmp_gt_u32 s80, 100000
    s_cbranch_scc1 SPD_26
    s_sleep 4
    s_branch SP_25
SPD_26:
    buffer_load_dwordx4 v[112:115], v4, s[12:15], s72 offen sc1
    buffer_load_dwordx4 v[116:119], v4, s[12:15], s72 offen offset:2304 sc1
    buffer_load_dwordx4 v[120:123], v4, s[12:15], s73 offen sc1
    buffer_load_dwordx2 v[124:125], v4, s[12:15], s72 offen offset:16 sc1
    buffer_load_dwordx2 v[126:127], v4, s[12:15], s72 offen offset:2320 sc1
    buffer_load_dwordx2 v[128:129], v4, s[12:15], s73 offen offset:16 sc1
    buffer_load_dword v14, v8, s[12:15], s70 offen sc1
    buffer_load_dwordx2 v[130:131], v7, s[28:31], s71 offen
    buffer_load_dword v132, v7, s[28:31], s71 offen offset:8
    buffer_load_ushort v12, v6, s[28:31], 0 offen
    buffer_load_ushort v13, v2, s[20:23], s4 offen
    buffer_load_ushort v15, v9, s[24:27], s5 offen
    v_lshrrev_b32 v2, 5, v1
    v_lshlrev_b32 v6, 5, v2
    v_lshlrev_b32 v2, 4, v2
    v_sub_u32 v2, 16, v2
    s_waitcnt vmcnt(0)
    v_lshlrev_b32 v112, v2, v112
    v_and_b32 v148, 0xffff0000, v112
    v_lshlrev_b32 v113, v2, v113
    v_and_b32 v149, 0xffff0000, v113
    v_lshlrev_b32 v114, v2, v114
    v_and_b32 v150, 0xffff0000, v114
    v_lshlrev_b32 v115, v2, v115
    v_and_b32 v151, 0xffff0000, v115
    v_lshlrev_b32 v124, v2, v124
    v_and_b32 v162, 0xffff0000, v124
    v_lshlrev_b32 v125, v2, v125
    v_and_b32 v163, 0xffff0000, v125
    v_lshlrev_b32 v116, v2, v116
    v_and_b32 v156, 0xffff0000, v116
    v_lshlrev_b32 v117, v2, v117
    v_and_b32 v157, 0xffff0000, v117
    v_lshlrev_b32 v118, v2, v118
    v_and_b32 v158, 0xffff0000, v118
    v_lshlrev_b32 v119, v2, v119
    v_and_b32 v159, 0xffff0000, v119
    v_lshlrev_b32 v126, v2, v126
    v_and_b32 v166, 0xffff0000, v126
    v_lshlrev_b32 v127, v2, v127
    v_and_b32 v167, 0xffff0000, v127
    v_lshlrev_b32 v120, v2, v120
    v_and_b32 v152, 0xffff0000, v120
    v_lshlrev_b32 v121, v2, v121
    v_and_b32 v153, 0xffff0000, v121
    v_lshlrev_b32 v122, v2, v122
    v_and_b32 v154, 0xffff0000, v122
    v_lshlrev_b32 v123, v2, v123
    v_and_b32 v155, 0xffff0000, v123
    v_lshlrev_b32 v128, v2, v128
    v_and_b32 v164, 0xffff0000, v128
    v_lshlrev_b32 v129, v2, v129
    v_and_b32 v165, 0xffff0000, v129
    v_add_f32 v152, 1.0, v152
    v_add_f32 v153, 1.0, v153
    v_add_f32 v154, 1.0, v154
    v_add_f32 v155, 1.0, v155
    v_add_f32 v164, 1.0, v164
    v_add_f32 v165, 1.0, v165
    v_cvt_pk_bf16_f32 v3, v152, v153
    v_cvt_pk_bf16_f32 v4, v154, v155
    v_cvt_pk_bf16_f32 v5, v164, v165
    v_lshlrev_b32 v152, 16, v3
    v_and_b32 v153, 0xffff0000, v3
    v_lshlrev_b32 v154, 16, v4
    v_and_b32 v155, 0xffff0000, v4
    v_lshlrev_b32 v164, 16, v5
    v_and_b32 v165, 0xffff0000, v5
    v_and_b32 v145, 0xffff0000, v130
    v_lshlrev_b32 v144, 16, v130
    v_and_b32 v147, 0xffff0000, v131
    v_lshlrev_b32 v146, 16, v131
    v_and_b32 v161, 0xffff0000, v132
    v_lshlrev_b32 v160, 16, v132
    s_lshl_b32 s72, s76, 4
    s_sub_u32 s72, 16, s72
    v_lshlrev_b32 v14, s72, v14
    v_and_b32 v14, 0xffff0000, v14
    v_lshlrev_b32 v13, 16, v13
    v_lshlrev_b32 v15, 16, v15
    v_lshlrev_b32 v12, 16, v12
    s_mov_b32 exec_lo, 1
    s_mov_b32 exec_hi, 1
    ds_write_b32 v6, v12 offset:17472
    s_mov_b64 exec, -1
    s_mov_b32 s24, s52
    s_and_b32 s25, s53, 0xffff
    s_mov_b32 s26, 5308416
    s_mov_b32 s27, 0x00020000
    s_bitcmp1_b32 s100, 31
    s_cbranch_scc1 L_f_w1d
    s_mov_b32 s80, 0
SP_27:
    ds_read_b32 v7, v0 offset:40
    s_waitcnt lgkmcnt(0)
    v_readfirstlane_b32 s81, v7
    s_cmp_ge_u32 s81, 1
    s_nop 2
    s_cbranch_scc1 SPD_28
    s_add_u32 s80, s80, 1
    s_cmp_gt_u32 s80, 100000
    s_cbranch_scc1 SPD_28
    s_sleep 1
    s_branch SP_27
SPD_28:
    s_mov_b32 s70, 9216
    v_lshrrev_b32 v2, 2, v1
    v_and_b32 v8, 3, v1
    v_lshlrev_b32 v8, 4, v8
    v_mul_u32_u24 v3, 9216, v2
    v_lshl_add_u32 v4, v3, 3, v8
    v_lshl_add_u32 v5, v3, 2, v8
    s_lshl_b32 s72, s101, 6
    s_mul_i32 s73, s3, 1179648
    s_add_u32 s73, s73, s72
    buffer_load_dwordx4 v[16:19], v4, s[16:19], s73 offen nt
    s_add_u32 s73, s73, s70
    buffer_load_dwordx4 v[20:23], v4, s[16:19], s73 offen nt
    s_add_u32 s73, s73, s70
    buffer_load_dwordx4 v[24:27], v4, s[16:19], s73 offen nt
    s_add_u32 s73, s73, s70
    buffer_load_dwordx4 v[28:31], v4, s[16:19], s73 offen nt
    s_add_u32 s73, s73, s70
    buffer_load_dwordx4 v[32:35], v4, s[16:19], s73 offen nt
    s_add_u32 s73, s73, s70
    buffer_load_dwordx4 v[36:39], v4, s[16:19], s73 offen nt
    s_add_u32 s73, s73, s70
    buffer_load_dwordx4 v[40:43], v4, s[16:19], s73 offen nt
    s_add_u32 s73, s73, s70
    buffer_load_dwordx4 v[44:47], v4, s[16:19], s73 offen nt
    s_cmp_lg_u32 s3, 3
    s_cbranch_scc1 NX_29
    s_lshl_b32 s73, s70, 9
    s_add_u32 s73, s73, s72
    buffer_load_dwordx4 v[80:83], v5, s[16:19], s73 offen nt
    s_add_u32 s73, s73, s70
    buffer_load_dwordx4 v[84:87], v5, s[16:19], s73 offen nt
    s_add_u32 s73, s73, s70
    buffer_load_dwordx4 v[88:91], v5, s[16:19], s73 offen nt
    s_add_u32 s73, s73, s70
    buffer_load_dwordx4 v[92:95], v5, s[16:19], s73 offen nt
NX_29:
L_f_w1d:
    s_mov_b32 s80, 0
SP_30:
    ds_read_b32 v7, v0 offset:40
    s_waitcnt lgkmcnt(0)
    v_readfirstlane_b32 s81, v7
    s_cmp_ge_u32 s81, 1
    s_nop 2
    s_cbranch_scc1 SPD_31
    s_add_u32 s80, s80, 1
    s_cmp_gt_u32 s80, 100000
    s_cbranch_scc1 SPD_31
    s_sleep 1
    s_branch SP_30
SPD_31:
    v_lshrrev_b32 v2, 4, v1
    v_mul_u32_u24 v2, 1152, v2
    v_and_b32 v3, 15, v1
    v_lshl_add_u32 v2, v3, 4, v2
    s_mul_i32 s70, s101, 36864
    s_lshl_b32 s71, s3, 8
    s_add_u32 s71, s71, s70
    buffer_load_dwordx4 v[112:115], v2, s[24:27], s71 offen nt
    s_add_u32 s71, s71, 4608
    buffer_load_dwordx4 v[116:119], v2, s[24:27], s71 offen nt
    s_add_u32 s71, s71, 4608
    buffer_load_dwordx4 v[120:123], v2, s[24:27], s71 offen nt
    s_add_u32 s71, s71, 4608
    buffer_load_dwordx4 v[124:127], v2, s[24:27], s71 offen nt
    s_add_u32 s71, s71, 4608
    buffer_load_dwordx4 v[128:131], v2, s[24:27], s71 offen nt
    s_add_u32 s71, s71, 4608
    buffer_load_dwordx4 v[132:135], v2, s[24:27], s71 offen nt
    s_add_u32 s71, s71, 4608
    buffer_load_dwordx4 v[136:139], v2, s[24:27], s71 offen nt
    s_add_u32 s71, s71, 4608
    buffer_load_dwordx4 v[140:143], v2, s[24:27], s71 offen nt
    s_cmp_lg_u32 s3, 2
    s_cbranch_scc1 W2X_32
    s_add_u32 s71, s70, 1024
    s_mov_b32 exec_lo, 0x00ff00ff
    s_mov_b32 exec_hi, 0x00ff00ff
    buffer_load_dwordx4 v[80:83], v2, s[24:27], s71 offen nt
    s_add_u32 s71, s71, 4608
    buffer_load_dwordx4 v[84:87], v2, s[24:27], s71 offen nt
    s_add_u32 s71, s71, 4608
    buffer_load_dwordx4 v[88:91], v2, s[24:27], s71 offen nt
    s_add_u32 s71, s71, 4608
    buffer_load_dwordx4 v[92:95], v2, s[24:27], s71 offen nt
    s_add_u32 s71, s71, 4608
    buffer_load_dwordx4 v[96:99], v2, s[24:27], s71 offen nt
    s_add_u32 s71, s71, 4608
    buffer_load_dwordx4 v[100:103], v2, s[24:27], s71 offen nt
    s_add_u32 s71, s71, 4608
    buffer_load_dwordx4 v[104:107], v2, s[24:27], s71 offen nt
    s_add_u32 s71, s71, 4608
    buffer_load_dwordx4 v[108:111], v2, s[24:27], s71 offen nt
    s_mov_b64 exec, -1
W2X_32:
    s_cmp_eq_u32 s3, 3
    s_cselect_b32 s66, 24, 16
    s_cselect_b32 s67, 12, 8
    s_movk_i32 s74, 256
    s_cselect_b32 s74, 384, s74
    v_lshrrev_b32 v2, 5, v1
    v_and_b32 v3, 31, v1
    v_mul_u32_u24 v8, s67, v3
    v_mul_u32_u24 v4, 1152, v2
    v_add_u32 v4, v4, v8
    s_lshl_b32 s72, s3, 8
    v_add_u32 v4, s72, v4
    v_mul_u32_u24 v5, 2304, v2
    v_mad_u32_u24 v5, s66, v3, v5
    s_lshl_b32 s72, s3, 9
    v_add_u32 v5, s72, v5
    v_lshlrev_b32 v6, 5, v2
    s_lshl_b32 s72, s3, 3
    v_add_u32 v6, s72, v6
    v_mad_u32_u24 v8, s74, v2, v8
    v_and_b32 v3, 1, v1
    v_lshlrev_b32 v7, 5, v3
    v_mul_u32_u24 v9, s74, v3
    v_lshrrev_b32 v2, 2, v1
    v_lshl_add_u32 v9, v2, 4, v9
    v_lshlrev_b32 v11, 2, v1
    s_lshl_b32 s75, s74, 1
    s_lshr_b32 s73, s101, 3
    s_and_b32 s73, s73, 0
    s_mul_i32 s73, s73, 20480
    s_mov_b32 s34, 0x00003f80
    s_mov_b32 s35, 0x3f800000
    v_lshrrev_b32 v10, 4, v1
    v_and_b32 v3, 3, v1
    v_lshlrev_b32 v3, 6, v3
    v_lshl_add_u32 v10, v10, 8, v3
    s_lshl_b32 s72, s3, 10
    v_add_u32 v10, s72, v10
    s_add_u32 s4, s73, 1114112
    s_add_u32 s5, s73, 1116416
    s_add_u32 s6, s73, 1118720
    s_add_u32 s7, s73, 1121024
    s_add_u32 s8, s73, 1123328
    s_add_u32 s9, s73, 1125632
    s_add_u32 s10, s73, 1127936
    s_add_u32 s11, s73, 1130240
    s_mov_b32 s28, s60
    s_and_b32 s29, s61, 0xffff
    s_mov_b32 s30, 2304
    s_mov_b32 s31, 0x00020000
    s_lshl_b32 s72, s3, 11
    s_add_u32 s72, s72, 24576
    s_lshl_b32 s73, s3, 10
    s_add_u32 s73, s73, 13312
    s_cmp_eq_u32 s3, 2
    s_cbranch_scc1 L_f_w16
    s_waitcnt vmcnt(8)
L_f_w16:
    s_waitcnt vmcnt(16)
    v_perm_b32 v48, v20, v16, s78
    v_perm_b32 v52, v20, v16, s79
    v_perm_b32 v49, v28, v24, s78
    v_perm_b32 v53, v28, v24, s79
    v_perm_b32 v50, v36, v32, s78
    v_perm_b32 v54, v36, v32, s79
    v_perm_b32 v51, v44, v40, s78
    v_perm_b32 v55, v44, v40, s79
    v_perm_b32 v56, v21, v17, s78
    v_perm_b32 v60, v21, v17, s79
    v_perm_b32 v57, v29, v25, s78
    v_perm_b32 v61, v29, v25, s79
    v_perm_b32 v58, v37, v33, s78
    v_perm_b32 v62, v37, v33, s79
    v_perm_b32 v59, v45, v41, s78
    v_perm_b32 v63, v45, v41, s79
    v_perm_b32 v64, v22, v18, s78
    v_perm_b32 v68, v22, v18, s79
    v_perm_b32 v65, v30, v26, s78
    v_perm_b32 v69, v30, v26, s79
    v_perm_b32 v66, v38, v34, s78
    v_perm_b32 v70, v38, v34, s79
    v_perm_b32 v67, v46, v42, s78
    v_perm_b32 v71, v46, v42, s79
    v_perm_b32 v72, v23, v19, s78
    v_perm_b32 v76, v23, v19, s79
    v_perm_b32 v73, v31, v27, s78
    v_perm_b32 v77, v31, v27, s79
    v_perm_b32 v74, v39, v35, s78
    v_perm_b32 v78, v39, v35, s79
    v_perm_b32 v75, v47, v43, s78
    v_perm_b32 v79, v47, v43, s79
    s_cmp_lg_u32 s3, 3
    s_cbranch_scc1 L_f_x
    v_perm_b32 v96, v84, v80, s78
    v_perm_b32 v98, v84, v80, s79
    v_perm_b32 v97, v92, v88, s78
    v_perm_b32 v99, v92, v88, s79
    v_perm_b32 v100, v85, v81, s78
    v_perm_b32 v102, v85, v81, s79
    v_perm_b32 v101, v93, v89, s78
    v_perm_b32 v103, v93, v89, s79
    v_perm_b32 v104, v86, v82, s78
    v_perm_b32 v106, v86, v82, s79
    v_perm_b32 v105, v94, v90, s78
    v_perm_b32 v107, v94, v90, s79
    v_perm_b32 v108, v87, v83, s78
    v_perm_b32 v110, v87, v83, s79
    v_perm_b32 v109, v95, v91, s78
    v_perm_b32 v111, v95, v91, s79
    v_add_u32 v86, s72, v8
    v_add_u32 v87, s75, v86
    v_cvt_pk_bf16_f32 v2, v152, v153
    v_cvt_pk_bf16_f32 v3, v154, v155
    ds_write2_b32 v86, v2, v3 offset0:0 offset1:1
    v_cvt_pk_bf16_f32 v80, v164, v165
    ds_write_b32 v86, v80 offset:8
    v_cvt_pk_bf16_f32 v2, v156, v157
    v_cvt_pk_bf16_f32 v3, v158, v159
    ds_write2_b32 v87, v2, v3 offset0:0 offset1:1
    v_cvt_pk_bf16_f32 v80, v166, v167
    ds_write_b32 v87, v80 offset:8
    v_bfe_u32 v86, v1, 1, 1
    v_mul_u32_u24 v86, s75, v86
    v_add3_u32 v86, v86, v9, s72
    ds_read_b128 v[80:83], v86
    v_lshrrev_b32 v87, 2, v1
    v_lshlrev_b32 v87, 3, v87
    v_sub_u32 v86, v86, v87
    ds_read_b64 v[84:85], v86 offset:256
    v_mov_b32 v156, 0
    v_mov_b32 v157, 0
    v_mov_b32 v158, 0
    v_mov_b32 v159, 0
    v_mov_b32 v166, 0
    v_mov_b32 v167, 0
    v_add_u32 v8, s73, v8
    v_add_u32 v9, s73, v9
    v_sub_u32 v87, v9, v87
    v_lshlrev_b32 v86, 1, v10
    s_waitcnt lgkmcnt(0)
    v_mfma_f32_16x16x32_bf16 v[16:19], v[80:83], v[48:51], 0
    v_mfma_f32_16x16x32_bf16 v[20:23], v[80:83], v[52:55], 0
    v_mfma_f32_16x16x32_bf16 v[24:27], v[80:83], v[56:59], 0
    v_mfma_f32_16x16x32_bf16 v[28:31], v[80:83], v[60:63], 0
    v_mfma_f32_16x16x32_bf16 v[32:35], v[80:83], v[64:67], 0
    v_mfma_f32_16x16x32_bf16 v[36:39], v[80:83], v[68:71], 0
    v_mfma_f32_16x16x32_bf16 v[40:43], v[80:83], v[72:75], 0
    v_mfma_f32_16x16x32_bf16 v[44:47], v[80:83], v[76:79], 0
    v_mfma_f32_16x16x16_bf16 v[16:19], v[84:85], v[96:97], v[16:19]
    v_mfma_f32_16x16x16_bf16 v[20:23], v[84:85], v[98:99], v[20:23]
    v_mfma_f32_16x16x16_bf16 v[24:27], v[84:85], v[100:101], v[24:27]
    v_mfma_f32_16x16x16_bf16 v[28:31], v[84:85], v[102:103], v[28:31]
    v_mfma_f32_16x16x16_bf16 v[32:35], v[84:85], v[104:105], v[32:35]
    v_mfma_f32_16x16x16_bf16 v[36:39], v[84:85], v[106:107], v[36:39]
    v_mfma_f32_16x16x16_bf16 v[40:43], v[84:85], v[108:109], v[40:43]
    v_mfma_f32_16x16x16_bf16 v[44:47], v[84:85], v[110:111], v[44:47]
    s_mov_b32 exec_lo, 0x00f0000f
    s_mov_b32 exec_hi, 0xf0000f00
    ds_write_b128 v86, v[16:19] offset:32768
    ds_write_b128 v86, v[20:23] offset:32784
    ds_write_b128 v86, v[24:27] offset:32800
    ds_write_b128 v86, v[28:31] offset:32816
    ds_write_b128 v86, v[32:35] offset:32832
    ds_write_b128 v86, v[36:39] offset:32848
    ds_write_b128 v86, v[40:43] offset:32864
    ds_write_b128 v86, v[44:47] offset:32880
    s_mov_b64 exec, -1
    v_mov_b32 v2, 1
    s_mov_b64 exec, 1
    ds_add_rtn_u32 v2, v0, v2 offset:56
    s_mov_b64 exec, -1
    s_waitcnt lgkmcnt(0)
    v_readfirstlane_b32 s81, v2
    s_cmp_lg_u32 s81, 3
    s_nop 2
    s_cbranch_scc1 L_f_px
    v_lshrrev_b32 v2, 1, v1
    v_lshlrev_b32 v2, 4, v2
    v_and_b32 v3, 1, v1
    v_lshl_add_u32 v2, v3, 2, v2
    v_add_u32 v3, 8, v2
    ds_read2st64_b32 v[16:17], v2 offset0:128 offset1:130
    ds_read2st64_b32 v[18:19], v2 offset0:132 offset1:134
    ds_read2st64_b32 v[20:21], v2 offset0:136 offset1:138
    ds_read2st64_b32 v[22:23], v2 offset0:140 offset1:142
    ds_read2st64_b32 v[24:25], v2 offset0:144 offset1:146
    ds_read2st64_b32 v[26:27], v2 offset0:148 offset1:150
    ds_read2st64_b32 v[28:29], v2 offset0:152 offset1:154
    ds_read2st64_b32 v[30:31], v2 offset0:156 offset1:158
    s_waitcnt lgkmcnt(0)
    ds_read2st64_b32 v[32:33], v3 offset0:128 offset1:130
    ds_read2st64_b32 v[34:35], v3 offset0:132 offset1:134
    ds_read2st64_b32 v[36:37], v3 offset0:136 offset1:138
    ds_read2st64_b32 v[38:39], v3 offset0:140 offset1:142
    ds_read2st64_b32 v[40:41], v3 offset0:144 offset1:146
    ds_read2st64_b32 v[42:43], v3 offset0:148 offset1:150
    ds_read2st64_b32 v[44:45], v3 offset0:152 offset1:154
    ds_read2st64_b32 v[46:47], v3 offset0:156 offset1:158
    s_waitcnt lgkmcnt(0)
    v_pk_add_f32 v[16:17], v[16:17], v[18:19]
    v_pk_add_f32 v[20:21], v[20:21], v[22:23]
    v_pk_add_f32 v[24:25], v[24:25], v[26:27]
    v_pk_add_f32 v[28:29], v[28:29], v[30:31]
    v_pk_add_f32 v[16:17], v[16:17], v[20:21]
    v_pk_add_f32 v[24:25], v[24:25], v[28:29]
    v_pk_add_f32 v[16:17], v[16:17], v[24:25]
    v_pk_add_f32 v[32:33], v[32:33], v[34:35]
    v_pk_add_f32 v[36:37], v[36:37], v[38:39]
    v_pk_add_f32 v[40:41], v[40:41], v[42:43]
    v_pk_add_f32 v[44:45], v[44:45], v[46:47]
    v_pk_add_f32 v[32:33], v[32:33], v[36:37]
    v_pk_add_f32 v[40:41], v[40:41], v[44:45]
    v_pk_add_f32 v[32:33], v[32:33], v[40:41]
    v_add_f32 v2, v16, v17
    v_add_f32 v3, v32, v33
    v_lshlrev_b32 v16, 3, v1
    ds_write_b64 v16, v[2:3] offset:17536
L_f_px:
    s_waitcnt vmcnt(0)
    s_mov_b32 s80, 0
    s_mov_b32 s82, 255
PL_33:
    s_bitcmp1_b32 s82, 0
    s_cbranch_scc0 PI_38
    buffer_load_dwordx3 v[16:18], v4, s[12:15], s4 offen offset:0 sc1
PI_38:
    s_bitcmp1_b32 s82, 1
    s_cbranch_scc0 PI_39
    buffer_load_dwordx3 v[20:22], v4, s[12:15], s5 offen offset:0 sc1
PI_39:
    s_bitcmp1_b32 s82, 2
    s_cbranch_scc0 PI_40
    buffer_load_dwordx3 v[24:26], v4, s[12:15], s6 offen offset:0 sc1
PI_40:
    s_bitcmp1_b32 s82, 3
    s_cbranch_scc0 PI_41
    buffer_load_dwordx3 v[28:30], v4, s[12:15], s7 offen offset:0 sc1
PI_41:
    s_bitcmp1_b32 s82, 4
    s_cbranch_scc0 PI_42
    buffer_load_dwordx3 v[32:34], v4, s[12:15], s8 offen offset:0 sc1
PI_42:
    s_bitcmp1_b32 s82, 5
    s_cbranch_scc0 PI_43
    buffer_load_dwordx3 v[36:38], v4, s[12:15], s9 offen offset:0 sc1
PI_43:
    s_bitcmp1_b32 s82, 6
    s_cbranch_scc0 PI_44
    buffer_load_dwordx3 v[40:42], v4, s[12:15], s10 offen offset:0 sc1
PI_44:
    s_bitcmp1_b32 s82, 7
    s_cbranch_scc0 PI_45
    buffer_load_dwordx3 v[44:46], v4, s[12:15], s11 offen offset:0 sc1
PI_45:
PW_35:
    s_mov_b32 s81, s82
    s_waitcnt vmcnt(0)
PW_37:
    s_bitcmp1_b32 s81, 0
    s_cbranch_scc0 PC_46
    v_cmp_u_f32 vcc, v16, v17
    v_cmp_u_f32 s[66:67], v18, v18
    s_or_b64 vcc, vcc, s[66:67]
    s_nop 2
    s_cbranch_scc1 PC_46
    s_bitset0_b32 s82, 0
    v_dot2_f32_bf16 v156, v16, s34, v156
    v_dot2_f32_bf16 v157, v16, s35, v157
    v_dot2_f32_bf16 v158, v17, s34, v158
    v_dot2_f32_bf16 v159, v17, s35, v159
    v_dot2_f32_bf16 v166, v18, s34, v166
    v_dot2_f32_bf16 v167, v18, s35, v167
PC_46:
    s_bitcmp1_b32 s81, 1
    s_nop 0
    s_cbranch_scc0 PC_47
    v_cmp_u_f32 vcc, v20, v21
    v_cmp_u_f32 s[66:67], v22, v22
    s_or_b64 vcc, vcc, s[66:67]
    s_nop 2
    s_cbranch_scc1 PC_47
    s_bitset0_b32 s82, 1
    v_dot2_f32_bf16 v156, v20, s34, v156
    v_dot2_f32_bf16 v157, v20, s35, v157
    v_dot2_f32_bf16 v158, v21, s34, v158
    v_dot2_f32_bf16 v159, v21, s35, v159
    v_dot2_f32_bf16 v166, v22, s34, v166
    v_dot2_f32_bf16 v167, v22, s35, v167
PC_47:
    s_bitcmp1_b32 s81, 2
    s_nop 0
    s_cbranch_scc0 PC_48
    v_cmp_u_f32 vcc, v24, v25
    v_cmp_u_f32 s[66:67], v26, v26
    s_or_b64 vcc, vcc, s[66:67]
    s_nop 2
    s_cbranch_scc1 PC_48
    s_bitset0_b32 s82, 2
    v_dot2_f32_bf16 v156, v24, s34, v156
    v_dot2_f32_bf16 v157, v24, s35, v157
    v_dot2_f32_bf16 v158, v25, s34, v158
    v_dot2_f32_bf16 v159, v25, s35, v159
    v_dot2_f32_bf16 v166, v26, s34, v166
    v_dot2_f32_bf16 v167, v26, s35, v167
PC_48:
    s_bitcmp1_b32 s81, 3
    s_nop 0
    s_cbranch_scc0 PC_49
    v_cmp_u_f32 vcc, v28, v29
    v_cmp_u_f32 s[66:67], v30, v30
    s_or_b64 vcc, vcc, s[66:67]
    s_nop 2
    s_cbranch_scc1 PC_49
    s_bitset0_b32 s82, 3
    v_dot2_f32_bf16 v156, v28, s34, v156
    v_dot2_f32_bf16 v157, v28, s35, v157
    v_dot2_f32_bf16 v158, v29, s34, v158
    v_dot2_f32_bf16 v159, v29, s35, v159
    v_dot2_f32_bf16 v166, v30, s34, v166
    v_dot2_f32_bf16 v167, v30, s35, v167
PC_49:
    s_bitcmp1_b32 s81, 4
    s_nop 0
    s_cbranch_scc0 PC_50
    v_cmp_u_f32 vcc, v32, v33
    v_cmp_u_f32 s[66:67], v34, v34
    s_or_b64 vcc, vcc, s[66:67]
    s_nop 2
    s_cbranch_scc1 PC_50
    s_bitset0_b32 s82, 4
    v_dot2_f32_bf16 v156, v32, s34, v156
    v_dot2_f32_bf16 v157, v32, s35, v157
    v_dot2_f32_bf16 v158, v33, s34, v158
    v_dot2_f32_bf16 v159, v33, s35, v159
    v_dot2_f32_bf16 v166, v34, s34, v166
    v_dot2_f32_bf16 v167, v34, s35, v167
PC_50:
    s_bitcmp1_b32 s81, 5
    s_nop 0
    s_cbranch_scc0 PC_51
    v_cmp_u_f32 vcc, v36, v37
    v_cmp_u_f32 s[66:67], v38, v38
    s_or_b64 vcc, vcc, s[66:67]
    s_nop 2
    s_cbranch_scc1 PC_51
    s_bitset0_b32 s82, 5
    v_dot2_f32_bf16 v156, v36, s34, v156
    v_dot2_f32_bf16 v157, v36, s35, v157
    v_dot2_f32_bf16 v158, v37, s34, v158
    v_dot2_f32_bf16 v159, v37, s35, v159
    v_dot2_f32_bf16 v166, v38, s34, v166
    v_dot2_f32_bf16 v167, v38, s35, v167
PC_51:
    s_bitcmp1_b32 s81, 6
    s_nop 0
    s_cbranch_scc0 PC_52
    v_cmp_u_f32 vcc, v40, v41
    v_cmp_u_f32 s[66:67], v42, v42
    s_or_b64 vcc, vcc, s[66:67]
    s_nop 2
    s_cbranch_scc1 PC_52
    s_bitset0_b32 s82, 6
    v_dot2_f32_bf16 v156, v40, s34, v156
    v_dot2_f32_bf16 v157, v40, s35, v157
    v_dot2_f32_bf16 v158, v41, s34, v158
    v_dot2_f32_bf16 v159, v41, s35, v159
    v_dot2_f32_bf16 v166, v42, s34, v166
    v_dot2_f32_bf16 v167, v42, s35, v167
PC_52:
    s_bitcmp1_b32 s81, 7
    s_nop 0
    s_cbranch_scc0 PC_53
    v_cmp_u_f32 vcc, v44, v45
    v_cmp_u_f32 s[66:67], v46, v46
    s_or_b64 vcc, vcc, s[66:67]
    s_nop 2
    s_cbranch_scc1 PC_53
    s_bitset0_b32 s82, 7
    v_dot2_f32_bf16 v156, v44, s34, v156
    v_dot2_f32_bf16 v157, v44, s35, v157
    v_dot2_f32_bf16 v158, v45, s34, v158
    v_dot2_f32_bf16 v159, v45, s35, v159
    v_dot2_f32_bf16 v166, v46, s34, v166
    v_dot2_f32_bf16 v167, v46, s35, v167
PC_53:
    s_cmp_eq_u32 s82, 0
    s_nop 0
    s_cbranch_scc1 PLD_34
    s_add_u32 s80, s80, 1
    s_cmp_gt_u32 s80, 100000
    s_cbranch_scc1 PLD_34
    s_bcnt1_i32_b32 s81, s82
    s_cmp_le_u32 s81, 3
    s_cbranch_scc1 PL_33
    s_sleep 0
    s_branch PL_33
PLD_34:
    v_cvt_pk_bf16_f32 v32, v156, v157
    v_cvt_pk_bf16_f32 v33, v158, v159
    v_cvt_pk_bf16_f32 v34, v166, v167
    v_lshlrev_b32 v156, 16, v32
    v_and_b32 v157, 0xffff0000, v32
    v_lshlrev_b32 v158, 16, v33
    v_and_b32 v159, 0xffff0000, v33
    v_lshlrev_b32 v166, 16, v34
    v_and_b32 v167, 0xffff0000, v34
    v_pk_mul_f32 v[156:157], v[156:157], v[148:149]
    v_pk_mul_f32 v[158:159], v[158:159], v[150:151]
    v_pk_mul_f32 v[166:167], v[166:167], v[162:163]
    v_cvt_pk_bf16_f32 v32, v156, v157
    v_cvt_pk_bf16_f32 v33, v158, v159
    v_cvt_pk_bf16_f32 v34, v166, v167
    v_lshlrev_b32 v156, 16, v32
    v_and_b32 v157, 0xffff0000, v32
    v_lshlrev_b32 v158, 16, v33
    v_and_b32 v159, 0xffff0000, v33
    v_lshlrev_b32 v166, 16, v34
    v_and_b32 v167, 0xffff0000, v34
    v_pk_add_f32 v[156:157], v[156:157], v[144:145]
    v_pk_add_f32 v[158:159], v[158:159], v[146:147]
    v_pk_add_f32 v[166:167], v[166:167], v[160:161]
    v_cvt_pk_bf16_f32 v32, v156, v157
    v_cvt_pk_bf16_f32 v33, v158, v159
    v_cvt_pk_bf16_f32 v34, v166, v167
    v_lshlrev_b32 v156, 16, v32
    v_and_b32 v157, 0xffff0000, v32
    v_lshlrev_b32 v158, 16, v33
    v_and_b32 v159, 0xffff0000, v33
    v_lshlrev_b32 v166, 16, v34
    v_and_b32 v167, 0xffff0000, v34
    v_pk_add_f32 v[16:17], v[156:157], v[12:13] op_sel_hi:[1,0] neg_lo:[0,1] neg_hi:[0,1]
    v_pk_add_f32 v[18:19], v[158:159], v[12:13] op_sel_hi:[1,0] neg_lo:[0,1] neg_hi:[0,1]
    v_pk_add_f32 v[20:21], v[166:167], v[12:13] op_sel_hi:[1,0] neg_lo:[0,1] neg_hi:[0,1]
    v_pk_mul_f32 v[22:23], v[16:17], v[152:153]
    v_pk_mul_f32 v[24:25], v[18:19], v[154:155]
    v_pk_mul_f32 v[26:27], v[20:21], v[164:165]
    v_cvt_pk_bf16_f32 v2, v22, v23
    v_cvt_pk_bf16_f32 v3, v24, v25
    v_cvt_pk_bf16_f32 v22, v26, v27
    ds_write2_b32 v8, v2, v3 offset0:0 offset1:1
    ds_write_b32 v8, v22 offset:8
    ds_read_b128 v[144:147], v9
    ds_read_b64 v[148:149], v87 offset:256
    v_pk_add_f32 v[28:29], v[16:17], v[18:19]
    v_pk_mul_f32 v[30:31], v[16:17], v[16:17]
    v_pk_fma_f32 v[30:31], v[18:19], v[18:19], v[30:31]
    v_pk_add_f32 v[28:29], v[28:29], v[20:21]
    v_pk_fma_f32 v[30:31], v[20:21], v[20:21], v[30:31]
    v_add_f32 v2, v28, v29
    v_add_f32 v3, v30, v31
    s_nop 0
    v_add_f32_dpp v2, v2, v2 row_ror:8 row_mask:0xf bank_mask:0xf
    v_add_f32_dpp v3, v3, v3 row_ror:8 row_mask:0xf bank_mask:0xf
    s_nop 0
    v_add_f32_dpp v2, v2, v2 row_ror:4 row_mask:0xf bank_mask:0xf
    v_add_f32_dpp v3, v3, v3 row_ror:4 row_mask:0xf bank_mask:0xf
    s_nop 0
    v_add_f32_dpp v2, v2, v2 row_ror:2 row_mask:0xf bank_mask:0xf
    v_add_f32_dpp v3, v3, v3 row_ror:2 row_mask:0xf bank_mask:0xf
    s_nop 0
    v_add_f32_dpp v2, v2, v2 row_ror:1 row_mask:0xf bank_mask:0xf
    v_add_f32_dpp v3, v3, v3 row_ror:1 row_mask:0xf bank_mask:0xf
    v_mov_b32 v28, v2
    v_mov_b32 v30, v3
    s_nop 0
    v_permlane16_swap_b32 v2, v28
    v_permlane16_swap_b32 v3, v30
    v_add_f32 v2, v2, v28
    v_add_f32 v3, v3, v30
    s_mov_b32 exec_lo, 1
    s_mov_b32 exec_hi, 1
    ds_write_b64 v6, v[2:3] offset:17408
    s_mov_b64 exec, -1
    ds_write_b64 v5, v[156:157] offset:18432
    ds_write_b64 v5, v[158:159] offset:18440
    ds_write_b64 v5, v[166:167] offset:18448
    s_waitcnt lgkmcnt(4)
    v_mfma_f32_16x16x32_bf16 v[16:19], v[144:147], v[48:51], 0
    s_lshl_b32 s72, s3, 8
    s_add_u32 s72, s72, 23040
    v_bfe_u32 v4, v1, 3, 1
    v_mfma_f32_16x16x32_bf16 v[20:23], v[144:147], v[52:55], 0
    v_lshlrev_b32 v4, 7, v4
    v_lshrrev_b32 v5, 4, v1
    v_lshl_add_u32 v4, v5, 5, v4
    v_mfma_f32_16x16x32_bf16 v[24:27], v[144:147], v[56:59], 0
    v_add_u32 v4, s72, v4
    v_and_b32 v5, 1, v1
    v_lshlrev_b32 v12, 7, v5
    v_mfma_f32_16x16x32_bf16 v[28:31], v[144:147], v[60:63], 0
    v_lshlrev_b32 v5, 4, v5
    v_mov_b32 v6, 0xffff
    v_lshlrev_b32 v5, v5, v6
    v_mfma_f32_16x16x32_bf16 v[32:35], v[144:147], v[64:67], 0
    v_bfe_u32 v6, v1, 1, 2
    v_lshl_add_u32 v12, v6, 5, v12
    v_lshrrev_b32 v2, 3, v1
    v_mfma_f32_16x16x32_bf16 v[36:39], v[144:147], v[68:71], 0
    v_lshl_add_u32 v12, v2, 2, v12
    v_add_u32 v12, s72, v12
    v_cmp_eq_u32 vcc, 0, v6
    v_mfma_f32_16x16x32_bf16 v[40:43], v[144:147], v[72:75], 0
    v_cmp_eq_u32 s[66:67], 1, v6
    v_lshrrev_b32 v9, 5, v1
    v_cndmask_b32 v150, 0, v5, vcc
    v_mfma_f32_16x16x32_bf16 v[44:47], v[144:147], v[76:79], 0
    v_cndmask_b32 v151, 0, v5, s[66:67]
    v_cmp_eq_u32 vcc, 2, v6
    v_cmp_eq_u32 s[66:67], 3, v6
    v_mfma_f32_16x16x16_bf16 v[16:19], v[148:149], v[96:97], v[16:19]
    v_mul_u32_u24 v9, 2304, v9
    v_cndmask_b32 v152, 0, v5, vcc
    v_cndmask_b32 v153, 0, v5, s[66:67]
    v_mfma_f32_16x16x16_bf16 v[20:23], v[148:149], v[98:99], v[20:23]
    v_and_b32 v8, 15, v1
    v_lshl_add_u32 v9, v8, 5, v9
    v_bfe_u32 v8, v1, 4, 1
    v_mfma_f32_16x16x16_bf16 v[24:27], v[148:149], v[100:101], v[24:27]
    v_lshl_add_u32 v9, v8, 4, v9
    v_lshlrev_b32 v8, 3, v1
    v_mfma_f32_16x16x16_bf16 v[28:31], v[148:149], v[102:103], v[28:31]
    v_mfma_f32_16x16x16_bf16 v[32:35], v[148:149], v[104:105], v[32:35]
    v_mfma_f32_16x16x16_bf16 v[36:39], v[148:149], v[106:107], v[36:39]
    v_mfma_f32_16x16x16_bf16 v[40:43], v[148:149], v[108:109], v[40:43]
    v_mfma_f32_16x16x16_bf16 v[44:47], v[148:149], v[110:111], v[44:47]
    s_nop 6
    s_branch L_f_j
L_f_x:
    v_add_u32 v164, s72, v8
    v_add_u32 v165, s75, v164
    v_cvt_pk_bf16_f32 v2, v152, v153
    v_cvt_pk_bf16_f32 v3, v154, v155
    ds_write_b64 v164, v[2:3]
    v_cvt_pk_bf16_f32 v2, v156, v157
    v_cvt_pk_bf16_f32 v3, v158, v159
    ds_write_b64 v165, v[2:3]
    v_bfe_u32 v164, v1, 1, 1
    v_mul_u32_u24 v164, s75, v164
    v_add3_u32 v164, v164, v9, s72
    ds_read_b128 v[160:163], v164
    v_mov_b32 v156, 0
    v_mov_b32 v157, 0
    v_mov_b32 v158, 0
    v_mov_b32 v159, 0
    v_add_u32 v8, s73, v8
    v_add_u32 v9, s73, v9
    v_lshlrev_b32 v164, 1, v10
    s_waitcnt lgkmcnt(0)
    v_mfma_f32_16x16x32_bf16 v[16:19], v[160:163], v[48:51], 0
    v_mfma_f32_16x16x32_bf16 v[20:23], v[160:163], v[52:55], 0
    v_mfma_f32_16x16x32_bf16 v[24:27], v[160:163], v[56:59], 0
    v_mfma_f32_16x16x32_bf16 v[28:31], v[160:163], v[60:63], 0
    v_mfma_f32_16x16x32_bf16 v[32:35], v[160:163], v[64:67], 0
    v_mfma_f32_16x16x32_bf16 v[36:39], v[160:163], v[68:71], 0
    v_mfma_f32_16x16x32_bf16 v[40:43], v[160:163], v[72:75], 0
    v_mfma_f32_16x16x32_bf16 v[44:47], v[160:163], v[76:79], 0
    s_mov_b32 exec_lo, 0x00f0000f
    s_mov_b32 exec_hi, 0xf0000f00
    ds_write_b128 v164, v[16:19] offset:32768
    ds_write_b128 v164, v[20:23] offset:32784
    ds_write_b128 v164, v[24:27] offset:32800
    ds_write_b128 v164, v[28:31] offset:32816
    ds_write_b128 v164, v[32:35] offset:32832
    ds_write_b128 v164, v[36:39] offset:32848
    ds_write_b128 v164, v[40:43] offset:32864
    ds_write_b128 v164, v[44:47] offset:32880
    s_mov_b64 exec, -1
    v_mov_b32 v2, 1
    s_mov_b64 exec, 1
    ds_add_rtn_u32 v2, v0, v2 offset:56
    s_mov_b64 exec, -1
    s_waitcnt lgkmcnt(0)
    v_readfirstlane_b32 s81, v2
    s_cmp_lg_u32 s81, 3
    s_nop 2
    s_cbranch_scc1 L_f_pn
    v_lshrrev_b32 v2, 1, v1
    v_lshlrev_b32 v2, 4, v2
    v_and_b32 v3, 1, v1
    v_lshl_add_u32 v2, v3, 2, v2
    v_add_u32 v3, 8, v2
    ds_read2st64_b32 v[16:17], v2 offset0:128 offset1:130
    ds_read2st64_b32 v[18:19], v2 offset0:132 offset1:134
    ds_read2st64_b32 v[20:21], v2 offset0:136 offset1:138
    ds_read2st64_b32 v[22:23], v2 offset0:140 offset1:142
    ds_read2st64_b32 v[24:25], v2 offset0:144 offset1:146
    ds_read2st64_b32 v[26:27], v2 offset0:148 offset1:150
    ds_read2st64_b32 v[28:29], v2 offset0:152 offset1:154
    ds_read2st64_b32 v[30:31], v2 offset0:156 offset1:158
    s_waitcnt lgkmcnt(0)
    ds_read2st64_b32 v[32:33], v3 offset0:128 offset1:130
    ds_read2st64_b32 v[34:35], v3 offset0:132 offset1:134
    ds_read2st64_b32 v[36:37], v3 offset0:136 offset1:138
    ds_read2st64_b32 v[38:39], v3 offset0:140 offset1:142
    ds_read2st64_b32 v[40:41], v3 offset0:144 offset1:146
    ds_read2st64_b32 v[42:43], v3 offset0:148 offset1:150
    ds_read2st64_b32 v[44:45], v3 offset0:152 offset1:154
    ds_read2st64_b32 v[46:47], v3 offset0:156 offset1:158
    s_waitcnt lgkmcnt(0)
    v_pk_add_f32 v[16:17], v[16:17], v[18:19]
    v_pk_add_f32 v[20:21], v[20:21], v[22:23]
    v_pk_add_f32 v[24:25], v[24:25], v[26:27]
    v_pk_add_f32 v[28:29], v[28:29], v[30:31]
    v_pk_add_f32 v[16:17], v[16:17], v[20:21]
    v_pk_add_f32 v[24:25], v[24:25], v[28:29]
    v_pk_add_f32 v[16:17], v[16:17], v[24:25]
    v_pk_add_f32 v[32:33], v[32:33], v[34:35]
    v_pk_add_f32 v[36:37], v[36:37], v[38:39]
    v_pk_add_f32 v[40:41], v[40:41], v[42:43]
    v_pk_add_f32 v[44:45], v[44:45], v[46:47]
    v_pk_add_f32 v[32:33], v[32:33], v[36:37]
    v_pk_add_f32 v[40:41], v[40:41], v[44:45]
    v_pk_add_f32 v[32:33], v[32:33], v[40:41]
    v_add_f32 v2, v16, v17
    v_add_f32 v3, v32, v33
    v_lshlrev_b32 v16, 3, v1
    ds_write_b64 v16, v[2:3] offset:17536
L_f_pn:
    s_waitcnt vmcnt(0)
    s_mov_b32 s80, 0
    s_mov_b32 s82, 255
PL_54:
    s_bitcmp1_b32 s82, 0
    s_cbranch_scc0 PI_59
    buffer_load_dwordx2 v[16:17], v4, s[12:15], s4 offen offset:0 sc1
PI_59:
    s_bitcmp1_b32 s82, 1
    s_cbranch_scc0 PI_60
    buffer_load_dwordx2 v[18:19], v4, s[12:15], s5 offen offset:0 sc1
PI_60:
    s_bitcmp1_b32 s82, 2
    s_cbranch_scc0 PI_61
    buffer_load_dwordx2 v[20:21], v4, s[12:15], s6 offen offset:0 sc1
PI_61:
    s_bitcmp1_b32 s82, 3
    s_cbranch_scc0 PI_62
    buffer_load_dwordx2 v[22:23], v4, s[12:15], s7 offen offset:0 sc1
PI_62:
    s_bitcmp1_b32 s82, 4
    s_cbranch_scc0 PI_63
    buffer_load_dwordx2 v[24:25], v4, s[12:15], s8 offen offset:0 sc1
PI_63:
    s_bitcmp1_b32 s82, 5
    s_cbranch_scc0 PI_64
    buffer_load_dwordx2 v[26:27], v4, s[12:15], s9 offen offset:0 sc1
PI_64:
    s_bitcmp1_b32 s82, 6
    s_cbranch_scc0 PI_65
    buffer_load_dwordx2 v[28:29], v4, s[12:15], s10 offen offset:0 sc1
PI_65:
    s_bitcmp1_b32 s82, 7
    s_cbranch_scc0 PI_66
    buffer_load_dwordx2 v[30:31], v4, s[12:15], s11 offen offset:0 sc1
PI_66:
PW_56:
    s_mov_b32 s81, s82
    s_waitcnt vmcnt(0)
PW_58:
    s_bitcmp1_b32 s81, 0
    s_cbranch_scc0 PC_67
    v_cmp_u_f32 vcc, v16, v17
    s_cmp_lg_u64 vcc, 0
    s_nop 2
    s_cbranch_scc1 PC_67
    s_bitset0_b32 s82, 0
    v_dot2_f32_bf16 v156, v16, s34, v156
    v_dot2_f32_bf16 v157, v16, s35, v157
    v_dot2_f32_bf16 v158, v17, s34, v158
    v_dot2_f32_bf16 v159, v17, s35, v159
PC_67:
    s_bitcmp1_b32 s81, 1
    s_nop 0
    s_cbranch_scc0 PC_68
    v_cmp_u_f32 vcc, v18, v19
    s_cmp_lg_u64 vcc, 0
    s_nop 2
    s_cbranch_scc1 PC_68
    s_bitset0_b32 s82, 1
    v_dot2_f32_bf16 v156, v18, s34, v156
    v_dot2_f32_bf16 v157, v18, s35, v157
    v_dot2_f32_bf16 v158, v19, s34, v158
    v_dot2_f32_bf16 v159, v19, s35, v159
PC_68:
    s_bitcmp1_b32 s81, 2
    s_nop 0
    s_cbranch_scc0 PC_69
    v_cmp_u_f32 vcc, v20, v21
    s_cmp_lg_u64 vcc, 0
    s_nop 2
    s_cbranch_scc1 PC_69
    s_bitset0_b32 s82, 2
    v_dot2_f32_bf16 v156, v20, s34, v156
    v_dot2_f32_bf16 v157, v20, s35, v157
    v_dot2_f32_bf16 v158, v21, s34, v158
    v_dot2_f32_bf16 v159, v21, s35, v159
PC_69:
    s_bitcmp1_b32 s81, 3
    s_nop 0
    s_cbranch_scc0 PC_70
    v_cmp_u_f32 vcc, v22, v23
    s_cmp_lg_u64 vcc, 0
    s_nop 2
    s_cbranch_scc1 PC_70
    s_bitset0_b32 s82, 3
    v_dot2_f32_bf16 v156, v22, s34, v156
    v_dot2_f32_bf16 v157, v22, s35, v157
    v_dot2_f32_bf16 v158, v23, s34, v158
    v_dot2_f32_bf16 v159, v23, s35, v159
PC_70:
    s_bitcmp1_b32 s81, 4
    s_nop 0
    s_cbranch_scc0 PC_71
    v_cmp_u_f32 vcc, v24, v25
    s_cmp_lg_u64 vcc, 0
    s_nop 2
    s_cbranch_scc1 PC_71
    s_bitset0_b32 s82, 4
    v_dot2_f32_bf16 v156, v24, s34, v156
    v_dot2_f32_bf16 v157, v24, s35, v157
    v_dot2_f32_bf16 v158, v25, s34, v158
    v_dot2_f32_bf16 v159, v25, s35, v159
PC_71:
    s_bitcmp1_b32 s81, 5
    s_nop 0
    s_cbranch_scc0 PC_72
    v_cmp_u_f32 vcc, v26, v27
    s_cmp_lg_u64 vcc, 0
    s_nop 2
    s_cbranch_scc1 PC_72
    s_bitset0_b32 s82, 5
    v_dot2_f32_bf16 v156, v26, s34, v156
    v_dot2_f32_bf16 v157, v26, s35, v157
    v_dot2_f32_bf16 v158, v27, s34, v158
    v_dot2_f32_bf16 v159, v27, s35, v159
PC_72:
    s_bitcmp1_b32 s81, 6
    s_nop 0
    s_cbranch_scc0 PC_73
    v_cmp_u_f32 vcc, v28, v29
    s_cmp_lg_u64 vcc, 0
    s_nop 2
    s_cbranch_scc1 PC_73
    s_bitset0_b32 s82, 6
    v_dot2_f32_bf16 v156, v28, s34, v156
    v_dot2_f32_bf16 v157, v28, s35, v157
    v_dot2_f32_bf16 v158, v29, s34, v158
    v_dot2_f32_bf16 v159, v29, s35, v159
PC_73:
    s_bitcmp1_b32 s81, 7
    s_nop 0
    s_cbranch_scc0 PC_74
    v_cmp_u_f32 vcc, v30, v31
    s_cmp_lg_u64 vcc, 0
    s_nop 2
    s_cbranch_scc1 PC_74
    s_bitset0_b32 s82, 7
    v_dot2_f32_bf16 v156, v30, s34, v156
    v_dot2_f32_bf16 v157, v30, s35, v157
    v_dot2_f32_bf16 v158, v31, s34, v158
    v_dot2_f32_bf16 v159, v31, s35, v159
PC_74:
    s_cmp_eq_u32 s82, 0
    s_nop 0
    s_cbranch_scc1 PLD_55
    s_add_u32 s80, s80, 1
    s_cmp_gt_u32 s80, 100000
    s_cbranch_scc1 PLD_55
    s_bcnt1_i32_b32 s81, s82
    s_cmp_le_u32 s81, 3
    s_cbranch_scc1 PL_54
    s_sleep 0
    s_branch PL_54
PLD_55:
    v_cvt_pk_bf16_f32 v32, v156, v157
    v_cvt_pk_bf16_f32 v33, v158, v159
    v_lshlrev_b32 v156, 16, v32
    v_and_b32 v157, 0xffff0000, v32
    v_lshlrev_b32 v158, 16, v33
    v_and_b32 v159, 0xffff0000, v33
    v_pk_mul_f32 v[156:157], v[156:157], v[148:149]
    v_pk_mul_f32 v[158:159], v[158:159], v[150:151]
    v_cvt_pk_bf16_f32 v32, v156, v157
    v_cvt_pk_bf16_f32 v33, v158, v159
    v_lshlrev_b32 v156, 16, v32
    v_and_b32 v157, 0xffff0000, v32
    v_lshlrev_b32 v158, 16, v33
    v_and_b32 v159, 0xffff0000, v33
    v_pk_add_f32 v[156:157], v[156:157], v[144:145]
    v_pk_add_f32 v[158:159], v[158:159], v[146:147]
    v_cvt_pk_bf16_f32 v32, v156, v157
    v_cvt_pk_bf16_f32 v33, v158, v159
    v_lshlrev_b32 v156, 16, v32
    v_and_b32 v157, 0xffff0000, v32
    v_lshlrev_b32 v158, 16, v33
    v_and_b32 v159, 0xffff0000, v33
    v_pk_add_f32 v[16:17], v[156:157], v[12:13] op_sel_hi:[1,0] neg_lo:[0,1] neg_hi:[0,1]
    v_pk_add_f32 v[18:19], v[158:159], v[12:13] op_sel_hi:[1,0] neg_lo:[0,1] neg_hi:[0,1]
    v_pk_mul_f32 v[22:23], v[16:17], v[152:153]
    v_pk_mul_f32 v[24:25], v[18:19], v[154:155]
    v_cvt_pk_bf16_f32 v2, v22, v23
    v_cvt_pk_bf16_f32 v3, v24, v25
    ds_write_b64 v8, v[2:3]
    ds_read_b128 v[144:147], v9
    v_pk_add_f32 v[28:29], v[16:17], v[18:19]
    v_pk_mul_f32 v[30:31], v[16:17], v[16:17]
    v_pk_fma_f32 v[30:31], v[18:19], v[18:19], v[30:31]
    v_add_f32 v2, v28, v29
    v_add_f32 v3, v30, v31
    s_nop 0
    v_add_f32_dpp v2, v2, v2 row_ror:8 row_mask:0xf bank_mask:0xf
    v_add_f32_dpp v3, v3, v3 row_ror:8 row_mask:0xf bank_mask:0xf
    s_nop 0
    v_add_f32_dpp v2, v2, v2 row_ror:4 row_mask:0xf bank_mask:0xf
    v_add_f32_dpp v3, v3, v3 row_ror:4 row_mask:0xf bank_mask:0xf
    s_nop 0
    v_add_f32_dpp v2, v2, v2 row_ror:2 row_mask:0xf bank_mask:0xf
    v_add_f32_dpp v3, v3, v3 row_ror:2 row_mask:0xf bank_mask:0xf
    s_nop 0
    v_add_f32_dpp v2, v2, v2 row_ror:1 row_mask:0xf bank_mask:0xf
    v_add_f32_dpp v3, v3, v3 row_ror:1 row_mask:0xf bank_mask:0xf
    v_mov_b32 v28, v2
    v_mov_b32 v30, v3
    s_nop 0
    v_permlane16_swap_b32 v2, v28
    v_permlane16_swap_b32 v3, v30
    v_add_f32 v2, v2, v28
    v_add_f32 v3, v3, v30
    s_mov_b32 exec_lo, 1
    s_mov_b32 exec_hi, 1
    ds_write_b64 v6, v[2:3] offset:17408
    s_mov_b64 exec, -1
    ds_write_b128 v5, v[156:159] offset:18432
    s_waitcnt lgkmcnt(2)
    v_mfma_f32_16x16x32_bf16 v[16:19], v[144:147], v[48:51], 0
    s_lshl_b32 s72, s3, 8
    s_add_u32 s72, s72, 23040
    v_bfe_u32 v4, v1, 3, 1
    v_lshlrev_b32 v4, 7, v4
    v_lshrrev_b32 v5, 4, v1
    v_mfma_f32_16x16x32_bf16 v[20:23], v[144:147], v[52:55], 0
    v_lshl_add_u32 v4, v5, 5, v4
    v_add_u32 v4, s72, v4
    v_and_b32 v5, 1, v1
    v_lshlrev_b32 v12, 7, v5
    v_lshlrev_b32 v5, 4, v5
    v_mfma_f32_16x16x32_bf16 v[24:27], v[144:147], v[56:59], 0
    v_mov_b32 v6, 0xffff
    v_lshlrev_b32 v5, v5, v6
    v_bfe_u32 v6, v1, 1, 2
    v_lshl_add_u32 v12, v6, 5, v12
    v_lshrrev_b32 v2, 3, v1
    v_mfma_f32_16x16x32_bf16 v[28:31], v[144:147], v[60:63], 0
    v_lshl_add_u32 v12, v2, 2, v12
    v_add_u32 v12, s72, v12
    v_cmp_eq_u32 vcc, 0, v6
    v_cmp_eq_u32 s[66:67], 1, v6
    v_lshrrev_b32 v9, 5, v1
    v_mfma_f32_16x16x32_bf16 v[32:35], v[144:147], v[64:67], 0
    v_cndmask_b32 v150, 0, v5, vcc
    v_cndmask_b32 v151, 0, v5, s[66:67]
    v_cmp_eq_u32 vcc, 2, v6
    v_cmp_eq_u32 s[66:67], 3, v6
    v_mul_u32_u24 v9, 2304, v9
    v_mfma_f32_16x16x32_bf16 v[36:39], v[144:147], v[68:71], 0
    v_cndmask_b32 v152, 0, v5, vcc
    v_cndmask_b32 v153, 0, v5, s[66:67]
    v_and_b32 v8, 15, v1
    v_lshl_add_u32 v9, v8, 5, v9
    v_bfe_u32 v8, v1, 4, 1
    v_mfma_f32_16x16x32_bf16 v[40:43], v[144:147], v[72:75], 0
    v_lshl_add_u32 v9, v8, 4, v9
    v_lshlrev_b32 v8, 3, v1
    v_mfma_f32_16x16x32_bf16 v[44:47], v[144:147], v[76:79], 0
L_f_j:
    s_mov_b32 exec_lo, 0x00f0000f
    s_mov_b32 exec_hi, 0xf0000f00
    ds_write_b64 v10, v[16:17] offset:9216
    ds_write_b64 v10, v[20:21] offset:9224
    ds_write_b64 v10, v[24:25] offset:9232
    ds_write_b64 v10, v[28:29] offset:9240
    ds_write_b64 v10, v[32:33] offset:9248
    ds_write_b64 v10, v[36:37] offset:9256
    ds_write_b64 v10, v[40:41] offset:9264
    ds_write_b64 v10, v[44:45] offset:9272
    s_mov_b64 exec, -1
    s_mul_i32 s72, s101, 4608
    s_add_u32 s72, s72, 393216
    s_lshl_b32 s73, s3, 9
    s_add_u32 s73, s73, s72
    s_mov_b32 s74, 0x3ae38e39
    s_mov_b32 s75, 0x3ae38e39
    s_waitcnt lgkmcnt(0)
    s_barrier
    ds_read_b128 v[32:35], v7 offset:17408
    ds_read_b128 v[36:39], v7 offset:17424
    ds_read_b32 v40, v7 offset:17472
    ds_read_b64 v[42:43], v8 offset:17536
    ds_read2st64_b32 v[48:49], v11 offset0:36 offset1:37
    ds_read2st64_b32 v[50:51], v11 offset0:38 offset1:39
    ds_read2st64_b32 v[52:53], v11 offset0:40 offset1:41
    ds_read2st64_b32 v[54:55], v11 offset0:42 offset1:43
    ds_read2st64_b32 v[56:57], v11 offset0:44 offset1:45
    ds_read2st64_b32 v[58:59], v11 offset0:46 offset1:47
    ds_read2st64_b32 v[60:61], v11 offset0:48 offset1:49
    ds_read2st64_b32 v[62:63], v11 offset0:50 offset1:51
    v_mov_b32 v7, v9
    s_waitcnt lgkmcnt(9)
    v_pk_add_f32 v[32:33], v[32:33], v[34:35]
    v_pk_add_f32 v[36:37], v[36:37], v[38:39]
    v_pk_add_f32 v[32:33], v[32:33], v[36:37]
    v_pk_mul_f32 v[32:33], v[32:33], s[74:75]
    v_fma_f32 v33, -v32, v32, v33
    v_add_f32 v32, v32, v40
    v_max_f32 v33, 0, v33
    v_cvt_pk_bf16_f32 v34, v32, v33
    s_waitcnt lgkmcnt(4)
    v_pk_add_f32 v[48:49], v[48:49], v[50:51]
    v_and_b32 v33, 0xffff0000, v34
    v_lshlrev_b32 v32, 16, v34
    v_add_f32 v33, 0x3727c5ac, v33
    v_pk_add_f32 v[52:53], v[52:53], v[54:55]
    v_cvt_pk_bf16_f32 v34, v33, v33
    v_sub_f32 v32, v32, v40
    v_lshlrev_b32 v33, 16, v34
    v_pk_add_f32 v[48:49], v[48:49], v[52:53]
    v_sqrt_f32 v33, v33
    s_waitcnt lgkmcnt(0)
    v_pk_add_f32 v[56:57], v[56:57], v[58:59]
    v_cvt_pk_bf16_f32 v34, v33, v33
    v_pk_add_f32 v[60:61], v[60:61], v[62:63]
    v_lshlrev_b32 v33, 16, v34
    v_pk_add_f32 v[56:57], v[56:57], v[60:61]
    v_rcp_f32 v33, v33
    v_pk_add_f32 v[48:49], v[48:49], v[56:57]
    v_add_f32 v3, v48, v49
    v_fma_f32 v3, -v32, v42, v3
    v_fma_f32 v3, v3, v33, v43
    v_cvt_pk_bf16_f32 v2, v3, v3
    v_lshlrev_b32 v3, 16, v2
    v_add_f32 v3, v3, v13
    v_cvt_pk_bf16_f32 v2, v3, v3
    v_lshlrev_b32 v3, 16, v2
    v_max_f32 v3, 0, v3
    v_mul_f32 v3, v3, v3
    v_cvt_pk_bf16_f32 v3, v3, v3
    ds_write_b32 v12, v3
    ds_read_b128 v[16:19], v4
    ds_read_b128 v[20:23], v4 offset:16
    s_cmp_eq_u32 s3, 2
    s_cbranch_scc1 L_f2_x
    s_waitcnt lgkmcnt(1) vmcnt(0)
    v_and_b32 v154, v16, v150
    v_and_b32 v155, v16, v151
    v_and_b32 v156, v16, v152
    v_and_b32 v157, v16, v153
    v_and_b32 v158, v17, v150
    v_and_b32 v159, v17, v151
    v_and_b32 v160, v17, v152
    v_and_b32 v161, v17, v153
    v_mfma_f32_16x16x32_bf16 v[24:27], v[154:157], v[112:115], 0
    v_and_b32 v154, v18, v150
    v_and_b32 v155, v18, v151
    v_and_b32 v156, v18, v152
    v_and_b32 v157, v18, v153
    v_mfma_f32_16x16x32_bf16 v[24:27], v[158:161], v[116:119], v[24:27]
    v_and_b32 v158, v19, v150
    v_and_b32 v159, v19, v151
    v_and_b32 v160, v19, v152
    v_and_b32 v161, v19, v153
    v_mfma_f32_16x16x32_bf16 v[24:27], v[154:157], v[120:123], v[24:27]
    s_waitcnt lgkmcnt(0)
    v_and_b32 v154, v20, v150
    v_and_b32 v155, v20, v151
    v_and_b32 v156, v20, v152
    v_and_b32 v157, v20, v153
    v_mfma_f32_16x16x32_bf16 v[24:27], v[158:161], v[124:127], v[24:27]
    s_waitcnt lgkmcnt(0)
    v_and_b32 v158, v21, v150
    v_and_b32 v159, v21, v151
    v_and_b32 v160, v21, v152
    v_and_b32 v161, v21, v153
    v_mfma_f32_16x16x32_bf16 v[24:27], v[154:157], v[128:131], v[24:27]
    v_and_b32 v154, v22, v150
    v_and_b32 v155, v22, v151
    v_and_b32 v156, v22, v152
    v_and_b32 v157, v22, v153
    v_mfma_f32_16x16x32_bf16 v[24:27], v[158:161], v[132:135], v[24:27]
    v_and_b32 v158, v23, v150
    v_and_b32 v159, v23, v151
    v_and_b32 v160, v23, v152
    v_and_b32 v161, v23, v153
    v_mfma_f32_16x16x32_bf16 v[24:27], v[154:157], v[136:139], v[24:27]
    s_nop 0
    v_mfma_f32_16x16x32_bf16 v[24:27], v[158:161], v[140:143], v[24:27]
    v_lshrrev_b32 v2, 3, v1
    v_mul_u32_u24 v2, 4608, v2
    v_and_b32 v3, 7, v1
    v_lshl_add_u32 v2, v3, 4, v2
    s_lshl_b32 s74, s101, 7
    s_nop 2
    buffer_store_dwordx4 v[24:27], v7, s[12:15], s73 offen sc1
    s_nop 0
    s_branch L_f2_d
L_fw1:
    s_branch L_fw0r
L_f2_x:
    s_waitcnt lgkmcnt(1) vmcnt(0)
    v_and_b32 v154, v16, v150
    v_and_b32 v155, v16, v151
    v_and_b32 v156, v16, v152
    v_and_b32 v157, v16, v153
    v_and_b32 v158, v17, v150
    v_and_b32 v159, v17, v151
    v_and_b32 v160, v17, v152
    v_and_b32 v161, v17, v153
    v_mfma_f32_16x16x32_bf16 v[24:27], v[154:157], v[112:115], 0
    v_mfma_f32_16x16x32_bf16 v[28:31], v[154:157], v[80:83], 0
    v_and_b32 v154, v18, v150
    v_and_b32 v155, v18, v151
    v_and_b32 v156, v18, v152
    v_and_b32 v157, v18, v153
    v_mfma_f32_16x16x32_bf16 v[24:27], v[158:161], v[116:119], v[24:27]
    v_mfma_f32_16x16x32_bf16 v[28:31], v[158:161], v[84:87], v[28:31]
    v_and_b32 v158, v19, v150
    v_and_b32 v159, v19, v151
    v_and_b32 v160, v19, v152
    v_and_b32 v161, v19, v153
    v_mfma_f32_16x16x32_bf16 v[24:27], v[154:157], v[120:123], v[24:27]
    v_mfma_f32_16x16x32_bf16 v[28:31], v[154:157], v[88:91], v[28:31]
    s_waitcnt lgkmcnt(0)
    v_and_b32 v154, v20, v150
    v_and_b32 v155, v20, v151
    v_and_b32 v156, v20, v152
    v_and_b32 v157, v20, v153
    v_mfma_f32_16x16x32_bf16 v[24:27], v[158:161], v[124:127], v[24:27]
    v_mfma_f32_16x16x32_bf16 v[28:31], v[158:161], v[92:95], v[28:31]
    s_waitcnt lgkmcnt(0)
    v_and_b32 v158, v21, v150
    v_and_b32 v159, v21, v151
    v_and_b32 v160, v21, v152
    v_and_b32 v161, v21, v153
    v_mfma_f32_16x16x32_bf16 v[24:27], v[154:157], v[128:131], v[24:27]
    v_mfma_f32_16x16x32_bf16 v[28:31], v[154:157], v[96:99], v[28:31]
    v_and_b32 v154, v22, v150
    v_and_b32 v155, v22, v151
    v_and_b32 v156, v22, v152
    v_and_b32 v157, v22, v153
    v_mfma_f32_16x16x32_bf16 v[24:27], v[158:161], v[132:135], v[24:27]
    v_mfma_f32_16x16x32_bf16 v[28:31], v[158:161], v[100:103], v[28:31]
    v_and_b32 v158, v23, v150
    v_and_b32 v159, v23, v151
    v_and_b32 v160, v23, v152
    v_and_b32 v161, v23, v153
    v_mfma_f32_16x16x32_bf16 v[24:27], v[154:157], v[136:139], v[24:27]
    v_mfma_f32_16x16x32_bf16 v[28:31], v[154:157], v[104:107], v[28:31]
    v_mfma_f32_16x16x32_bf16 v[24:27], v[158:161], v[140:143], v[24:27]
    v_mfma_f32_16x16x32_bf16 v[28:31], v[158:161], v[108:111], v[28:31]
    v_lshrrev_b32 v2, 3, v1
    v_mul_u32_u24 v2, 4608, v2
    v_and_b32 v3, 7, v1
    v_lshl_add_u32 v2, v3, 4, v2
    s_lshl_b32 s74, s101, 7
    s_nop 1
    buffer_store_dwordx4 v[24:27], v7, s[12:15], s73 offen sc1
    s_mov_b32 exec_lo, 0x00ff00ff
    s_mov_b32 exec_hi, 0x00ff00ff
    buffer_store_dwordx4 v[28:31], v7, s[12:15], s72 offen offset:2048 sc1
    s_mov_b64 exec, -1
L_f2_d:
    s_cmp_ge_u32 s101, 36
    s_cbranch_scc1 L_fin_end
    s_mul_i32 s73, s3, 36864
    s_add_u32 s73, s73, s74
    s_add_u32 s4, s73, 393216
    s_add_u32 s5, s4, 147456
    s_add_u32 s6, s5, 147456
    s_add_u32 s7, s6, 147456
    s_add_u32 s8, s7, 147456
    v_lshrrev_b32 v8, 4, v1
    v_lshlrev_b32 v8, 7, v8
    v_lshl_add_u32 v8, v3, 4, v8
    s_lshl_b32 s75, s3, 9
    v_add_u32 v8, s75, v8
    v_and_b32 v9, 31, v1
    v_lshlrev_b32 v10, 2, v9
    v_add_u32 v11, s74, v10
    v_lshlrev_b32 v9, 1, v9
    s_lshr_b32 s74, s74, 1
    ds_read_b32 v12, v11 offset:18432
    s_cmp_lt_u32 s3, 2
    s_cbranch_scc1 L_fin_x
    s_mov_b32 s80, 0
    buffer_load_dwordx4 v[80:83], v2, s[12:15], s4 offen sc1
    buffer_load_dwordx4 v[84:87], v2, s[12:15], s5 offen sc1
    buffer_load_dwordx4 v[88:91], v2, s[12:15], s6 offen sc1
    buffer_load_dwordx4 v[92:95], v2, s[12:15], s7 offen sc1
    s_sleep 10
    buffer_load_dwordx4 v[100:103], v2, s[12:15], s4 offen sc1
    buffer_load_dwordx4 v[104:107], v2, s[12:15], s5 offen sc1
    buffer_load_dwordx4 v[108:111], v2, s[12:15], s6 offen sc1
    buffer_load_dwordx4 v[112:115], v2, s[12:15], s7 offen sc1
FP_75:
    s_waitcnt vmcnt(6)
    v_pk_add_f32 v[32:33], v[80:81], v[84:85]
    v_pk_add_f32 v[34:35], v[82:83], v[86:87]
    s_waitcnt vmcnt(5)
    v_pk_add_f32 v[32:33], v[32:33], v[88:89]
    v_pk_add_f32 v[34:35], v[34:35], v[90:91]
    s_waitcnt vmcnt(4)
    v_pk_add_f32 v[32:33], v[32:33], v[92:93]
    v_pk_add_f32 v[34:35], v[34:35], v[94:95]
    v_cmp_u_f32 s[66:67], v32, v33
    v_cmp_u_f32 vcc, v34, v35
    s_or_b64 s[66:67], s[66:67], vcc
    s_nop 2
    s_cbranch_scc0 FPE_76
    buffer_load_dwordx4 v[80:83], v2, s[12:15], s4 offen sc1
    buffer_load_dwordx4 v[84:87], v2, s[12:15], s5 offen sc1
    buffer_load_dwordx4 v[88:91], v2, s[12:15], s6 offen sc1
    buffer_load_dwordx4 v[92:95], v2, s[12:15], s7 offen sc1
    s_waitcnt vmcnt(6)
    v_pk_add_f32 v[32:33], v[100:101], v[104:105]
    v_pk_add_f32 v[34:35], v[102:103], v[106:107]
    s_waitcnt vmcnt(5)
    v_pk_add_f32 v[32:33], v[32:33], v[108:109]
    v_pk_add_f32 v[34:35], v[34:35], v[110:111]
    s_waitcnt vmcnt(4)
    v_pk_add_f32 v[32:33], v[32:33], v[112:113]
    v_pk_add_f32 v[34:35], v[34:35], v[114:115]
    v_cmp_u_f32 s[66:67], v32, v33
    v_cmp_u_f32 vcc, v34, v35
    s_or_b64 s[66:67], s[66:67], vcc
    s_nop 2
    s_cbranch_scc0 FPE_76
    buffer_load_dwordx4 v[100:103], v2, s[12:15], s4 offen sc1
    buffer_load_dwordx4 v[104:107], v2, s[12:15], s5 offen sc1
    buffer_load_dwordx4 v[108:111], v2, s[12:15], s6 offen sc1
    buffer_load_dwordx4 v[112:115], v2, s[12:15], s7 offen sc1
    s_add_u32 s80, s80, 1
    s_cmp_gt_u32 s80, 100000
    s_cbranch_scc0 FP_75
FPE_76:
    s_branch L_fin_d
L_fin_x:
    s_mov_b32 s80, 0
    buffer_load_dwordx4 v[80:83], v2, s[12:15], s4 offen sc1
    buffer_load_dwordx4 v[84:87], v2, s[12:15], s5 offen sc1
    buffer_load_dwordx4 v[88:91], v2, s[12:15], s6 offen sc1
    buffer_load_dwordx4 v[92:95], v2, s[12:15], s7 offen sc1
    buffer_load_dwordx4 v[96:99], v2, s[12:15], s8 offen sc1
    s_sleep 10
    buffer_load_dwordx4 v[100:103], v2, s[12:15], s4 offen sc1
    buffer_load_dwordx4 v[104:107], v2, s[12:15], s5 offen sc1
    buffer_load_dwordx4 v[108:111], v2, s[12:15], s6 offen sc1
    buffer_load_dwordx4 v[112:115], v2, s[12:15], s7 offen sc1
    buffer_load_dwordx4 v[116:119], v2, s[12:15], s8 offen sc1
FP_77:
    s_waitcnt vmcnt(8)
    v_pk_add_f32 v[32:33], v[80:81], v[84:85]
    v_pk_add_f32 v[34:35], v[82:83], v[86:87]
    s_waitcnt vmcnt(7)
    v_pk_add_f32 v[32:33], v[32:33], v[88:89]
    v_pk_add_f32 v[34:35], v[34:35], v[90:91]
    s_waitcnt vmcnt(6)
    v_pk_add_f32 v[32:33], v[32:33], v[92:93]
    v_pk_add_f32 v[34:35], v[34:35], v[94:95]
    s_waitcnt vmcnt(5)
    v_pk_add_f32 v[32:33], v[32:33], v[96:97]
    v_pk_add_f32 v[34:35], v[34:35], v[98:99]
    v_cmp_u_f32 s[66:67], v32, v33
    v_cmp_u_f32 vcc, v34, v35
    s_or_b64 s[66:67], s[66:67], vcc
    s_nop 2
    s_cbranch_scc0 FPE_78
    buffer_load_dwordx4 v[80:83], v2, s[12:15], s4 offen sc1
    buffer_load_dwordx4 v[84:87], v2, s[12:15], s5 offen sc1
    buffer_load_dwordx4 v[88:91], v2, s[12:15], s6 offen sc1
    buffer_load_dwordx4 v[92:95], v2, s[12:15], s7 offen sc1
    buffer_load_dwordx4 v[96:99], v2, s[12:15], s8 offen sc1
    s_waitcnt vmcnt(8)
    v_pk_add_f32 v[32:33], v[100:101], v[104:105]
    v_pk_add_f32 v[34:35], v[102:103], v[106:107]
    s_waitcnt vmcnt(7)
    v_pk_add_f32 v[32:33], v[32:33], v[108:109]
    v_pk_add_f32 v[34:35], v[34:35], v[110:111]
    s_waitcnt vmcnt(6)
    v_pk_add_f32 v[32:33], v[32:33], v[112:113]
    v_pk_add_f32 v[34:35], v[34:35], v[114:115]
    s_waitcnt vmcnt(5)
    v_pk_add_f32 v[32:33], v[32:33], v[116:117]
    v_pk_add_f32 v[34:35], v[34:35], v[118:119]
    v_cmp_u_f32 s[66:67], v32, v33
    v_cmp_u_f32 vcc, v34, v35
    s_or_b64 s[66:67], s[66:67], vcc
    s_nop 2
    s_cbranch_scc0 FPE_78
    buffer_load_dwordx4 v[100:103], v2, s[12:15], s4 offen sc1
    buffer_load_dwordx4 v[104:107], v2, s[12:15], s5 offen sc1
    buffer_load_dwordx4 v[108:111], v2, s[12:15], s6 offen sc1
    buffer_load_dwordx4 v[112:115], v2, s[12:15], s7 offen sc1
    buffer_load_dwordx4 v[116:119], v2, s[12:15], s8 offen sc1
    s_add_u32 s80, s80, 1
    s_cmp_gt_u32 s80, 100000
    s_cbranch_scc0 FP_77
FPE_78:
L_fin_d:
    v_add_f32_dpp v32, v32, v32 row_ror:8 row_mask:0xf bank_mask:0xf
    v_add_f32_dpp v33, v33, v33 row_ror:8 row_mask:0xf bank_mask:0xf
    v_add_f32_dpp v34, v34, v34 row_ror:8 row_mask:0xf bank_mask:0xf
    v_add_f32_dpp v35, v35, v35 row_ror:8 row_mask:0xf bank_mask:0xf
    s_mov_b32 exec_lo, 0x00ff00ff
    s_mov_b32 exec_hi, 0x00ff00ff
    ds_write_b128 v8, v[32:35] offset:9216
    s_mov_b64 exec, -1
    v_mov_b32 v2, 1
    s_mov_b64 exec, 1
    ds_add_rtn_u32 v2, v0, v2 offset:24
    s_mov_b64 exec, -1
    s_waitcnt lgkmcnt(0)
    v_readfirstlane_b32 s81, v2
    s_cmp_lg_u32 s81, 3
    s_nop 2
    s_cbranch_scc1 L_fin_end
    ds_read_b32 v48, v10 offset:9216
    ds_read_b32 v49, v10 offset:9344
    ds_read_b32 v50, v10 offset:9472
    ds_read_b32 v51, v10 offset:9600
    ds_read_b32 v52, v10 offset:9728
    ds_read_b32 v53, v10 offset:9856
    ds_read_b32 v54, v10 offset:9984
    ds_read_b32 v55, v10 offset:10112
    ds_read_b32 v56, v10 offset:10240
    ds_read_b32 v57, v10 offset:10368
    ds_read_b32 v58, v10 offset:10496
    ds_read_b32 v59, v10 offset:10624
    ds_read_b32 v60, v10 offset:10752
    ds_read_b32 v61, v10 offset:10880
    ds_read_b32 v62, v10 offset:11008
    ds_read_b32 v63, v10 offset:11136
    s_waitcnt lgkmcnt(12)
    v_pk_add_f32 v[48:49], v[48:49], v[50:51]
    s_waitcnt lgkmcnt(8)
    v_pk_add_f32 v[52:53], v[52:53], v[54:55]
    s_waitcnt lgkmcnt(4)
    v_pk_add_f32 v[56:57], v[56:57], v[58:59]
    s_waitcnt lgkmcnt(0)
    v_pk_add_f32 v[60:61], v[60:61], v[62:63]
    v_pk_add_f32 v[48:49], v[48:49], v[52:53]
    v_pk_add_f32 v[56:57], v[56:57], v[60:61]
    v_pk_add_f32 v[48:49], v[48:49], v[56:57]
    v_add_f32 v48, v48, v49
    v_cvt_pk_bf16_f32 v2, v48, v48
    v_lshlrev_b32 v48, 16, v2
    v_add_f32 v48, v48, v15
    v_cvt_pk_bf16_f32 v2, v48, v48
    v_lshlrev_b32 v48, 16, v2
    v_mul_f32 v48, v48, v14
    v_cvt_pk_bf16_f32 v2, v48, v48
    v_lshlrev_b32 v48, 16, v2
    v_add_f32 v48, v48, v12
    v_cvt_pk_bf16_f32 v6, v48, v48
    s_mov_b32 exec_hi, 0
    buffer_store_short v6, v9, s[28:31], s74 offen
    s_mov_b64 exec, -1
    s_cmp_lg_u32 s101, 0
    s_cbranch_scc1 L_fin_end
    v_mov_b32 v8, s32
    v_mov_b32 v9, s33
    s_mov_b32 s70, 389120
    s_mov_b64 exec, 1
    buffer_store_dwordx2 v[8:9], v0, s[12:15], s70 offen sc1
    s_mov_b64 exec, -1
L_fin_end:
    s_endpgm
L_t_o:
    s_mov_b32 s20, s44
    s_and_b32 s21, s45, 0xffff
    s_mov_b32 s22, 4718592
    s_mov_b32 s23, 0x00020000
    s_mov_b32 s71, s101
    s_mul_i32 s76, s71, 57
    s_lshr_b32 s76, s76, 9
    s_mul_i32 s73, s76, 9
    s_sub_u32 s77, s71, s73
    v_lshrrev_b32 v2, 3, v1
    v_mul_u32_u24 v2, 9216, v2
    v_and_b32 v3, 7, v1
    v_lshl_add_u32 v2, v3, 4, v2
    s_lshr_b32 s73, s3, 1
    s_mul_i32 s73, s73, 8
    s_mul_i32 s75, s76, 1
    s_add_u32 s75, s75, s73
    s_lshl_b32 s72, s75, 1
    s_and_b32 s73, s3, 1
    s_add_u32 s72, s72, s73
    s_mul_i32 s72, s72, 147456
    s_lshl_b32 s73, s77, 7
    s_add_u32 s72, s72, s73
    s_mov_b64 exec, 1
    buffer_load_dword v16, v0, s[20:23], s72 offen
    s_mov_b64 exec, -1
    v_lshrrev_b32 v12, 5, v1
    v_lshlrev_b32 v12, 12, v12
    v_and_b32 v3, 7, v1
    v_lshl_add_u32 v12, v3, 5, v12
    s_lshl_b32 s68, s75, 8
    s_and_b32 s71, s3, 1
    s_lshl_b32 s71, s71, 4
    s_add_u32 s68, s68, s71
    s_add_u32 s68, s68, 368640
    s_nop 0
    s_mov_b32 s80, 0
SP_79:
    ds_read_b32 v3, v0 offset:28
    s_waitcnt lgkmcnt(0)
    v_readfirstlane_b32 s81, v3
    s_cmp_ge_u32 s81, 8
    s_nop 2
    s_cbranch_scc1 SPD_80
    s_add_u32 s80, s80, 1
    s_cmp_gt_u32 s80, 100000
    s_cbranch_scc1 SPD_80
    s_sleep 2
    s_branch SP_79
SPD_80:
    buffer_load_dwordx4 v[160:163], v12, s[12:15], s68 offen sc1
    s_add_u32 s73, s72, 0
    buffer_load_dwordx4 v[16:19], v2, s[20:23], s73 offen offset:0 nt
    s_add_u32 s73, s72, 0
    buffer_load_dwordx4 v[20:23], v2, s[20:23], s73 offen offset:1152 nt
    s_add_u32 s73, s72, 0
    buffer_load_dwordx4 v[24:27], v2, s[20:23], s73 offen offset:2304 nt
    s_add_u32 s73, s72, 0
    buffer_load_dwordx4 v[28:31], v2, s[20:23], s73 offen offset:3456 nt
    s_add_u32 s73, s72, 4096
    buffer_load_dwordx4 v[32:35], v2, s[20:23], s73 offen offset:512 nt
    s_add_u32 s73, s72, 4096
    buffer_load_dwordx4 v[36:39], v2, s[20:23], s73 offen offset:1664 nt
    s_add_u32 s73, s72, 4096
    buffer_load_dwordx4 v[40:43], v2, s[20:23], s73 offen offset:2816 nt
    s_add_u32 s73, s72, 4096
    buffer_load_dwordx4 v[44:47], v2, s[20:23], s73 offen offset:3968 nt
    s_add_u32 s73, s72, 73728
    buffer_load_dwordx4 v[80:83], v2, s[20:23], s73 offen offset:0 nt
    s_add_u32 s73, s72, 73728
    buffer_load_dwordx4 v[84:87], v2, s[20:23], s73 offen offset:1152 nt
    s_add_u32 s73, s72, 73728
    buffer_load_dwordx4 v[88:91], v2, s[20:23], s73 offen offset:2304 nt
    s_add_u32 s73, s72, 73728
    buffer_load_dwordx4 v[92:95], v2, s[20:23], s73 offen offset:3456 nt
    s_add_u32 s73, s72, 77824
    buffer_load_dwordx4 v[96:99], v2, s[20:23], s73 offen offset:512 nt
    s_add_u32 s73, s72, 77824
    buffer_load_dwordx4 v[100:103], v2, s[20:23], s73 offen offset:1664 nt
    s_add_u32 s73, s72, 77824
    buffer_load_dwordx4 v[104:107], v2, s[20:23], s73 offen offset:2816 nt
    s_add_u32 s73, s72, 77824
    buffer_load_dwordx4 v[108:111], v2, s[20:23], s73 offen offset:3968 nt
    v_lshrrev_b32 v4, 5, v1
    v_lshlrev_b32 v4, 17, v4
    v_and_b32 v3, 31, v1
    v_lshl_add_u32 v4, v3, 4, v4
    s_lshl_b32 s72, s75, 13
    s_and_b32 s73, s3, 1
    s_lshl_b32 s73, s73, 9
    s_add_u32 s72, s72, s73
    s_add_u32 s72, s72, 65536
    s_add_u32 s73, s72, 4096
    s_lshl_b32 s74, s3, 10
    s_add_u32 s75, s74, 13312
    v_lshlrev_b32 v8, 3, v1
    v_add_u32 v5, s75, v8
    v_lshrrev_b32 v6, 4, v1
    v_bfe_u32 v3, v1, 2, 1
    v_lshl_add_u32 v6, v6, 1, v3
    v_and_b32 v3, 1, v1
    v_lshlrev_b32 v3, 8, v3
    v_lshl_add_u32 v6, v6, 4, v3
    v_add_u32 v6, s75, v6
    v_and_b32 v7, 7, v1
    v_lshlrev_b32 v7, 5, v7
    v_lshrrev_b32 v3, 4, v1
    v_lshl_add_u32 v7, v3, 9, v7
    s_add_u32 s74, s74, 9216
    v_add_u32 v7, s74, v7
    v_and_b32 v9, 31, v1
    v_lshlrev_b32 v9, 2, v9
    v_lshrrev_b32 v3, 5, v1
    v_mul_u32_u24 v3, 1152, v3
    v_add_u32 v9, v9, v3
    s_mul_i32 s74, s76, 2304
    s_lshl_b32 s75, s77, 7
    s_add_u32 s74, s74, s75
    s_add_u32 s74, s74, 1114112
    s_mov_b32 s80, 0
SP_81:
    ds_read_b32 v3, v0 offset:36
    s_waitcnt lgkmcnt(0)
    v_readfirstlane_b32 s81, v3
    s_cmp_ge_u32 s81, 1
    s_nop 2
    s_cbranch_scc1 SPD_82
    s_add_u32 s80, s80, 1
    s_cmp_gt_u32 s80, 100000
    s_cbranch_scc1 SPD_82
    s_sleep 1
    s_branch SP_81
SPD_82:
    v_mov_b32 v164, 0
    v_mov_b32 v165, 0
    v_mov_b32 v166, 0
    v_mov_b32 v167, 0
    s_waitcnt vmcnt(8)
    v_perm_b32 v48, v20, v16, s78
    v_perm_b32 v52, v20, v16, s79
    v_perm_b32 v49, v28, v24, s78
    v_perm_b32 v53, v28, v24, s79
    v_perm_b32 v50, v36, v32, s78
    v_perm_b32 v54, v36, v32, s79
    v_perm_b32 v51, v44, v40, s78
    v_perm_b32 v55, v44, v40, s79
    v_perm_b32 v56, v21, v17, s78
    v_perm_b32 v60, v21, v17, s79
    v_perm_b32 v57, v29, v25, s78
    v_perm_b32 v61, v29, v25, s79
    v_perm_b32 v58, v37, v33, s78
    v_perm_b32 v62, v37, v33, s79
    v_perm_b32 v59, v45, v41, s78
    v_perm_b32 v63, v45, v41, s79
    v_perm_b32 v64, v22, v18, s78
    v_perm_b32 v68, v22, v18, s79
    v_perm_b32 v65, v30, v26, s78
    v_perm_b32 v69, v30, v26, s79
    v_perm_b32 v66, v38, v34, s78
    v_perm_b32 v70, v38, v34, s79
    v_perm_b32 v67, v46, v42, s78
    v_perm_b32 v71, v46, v42, s79
    v_perm_b32 v72, v23, v19, s78
    v_perm_b32 v76, v23, v19, s79
    v_perm_b32 v73, v31, v27, s78
    v_perm_b32 v77, v31, v27, s79
    v_perm_b32 v74, v39, v35, s78
    v_perm_b32 v78, v39, v35, s79
    v_perm_b32 v75, v47, v43, s78
    v_perm_b32 v79, v47, v43, s79
    s_waitcnt vmcnt(0)
    v_perm_b32 v112, v84, v80, s78
    v_perm_b32 v116, v84, v80, s79
    v_perm_b32 v113, v92, v88, s78
    v_perm_b32 v117, v92, v88, s79
    v_perm_b32 v114, v100, v96, s78
    v_perm_b32 v118, v100, v96, s79
    v_perm_b32 v115, v108, v104, s78
    v_perm_b32 v119, v108, v104, s79
    v_perm_b32 v120, v85, v81, s78
    v_perm_b32 v124, v85, v81, s79
    v_perm_b32 v121, v93, v89, s78
    v_perm_b32 v125, v93, v89, s79
    v_perm_b32 v122, v101, v97, s78
    v_perm_b32 v126, v101, v97, s79
    v_perm_b32 v123, v109, v105, s78
    v_perm_b32 v127, v109, v105, s79
    v_perm_b32 v128, v86, v82, s78
    v_perm_b32 v132, v86, v82, s79
    v_perm_b32 v129, v94, v90, s78
    v_perm_b32 v133, v94, v90, s79
    v_perm_b32 v130, v102, v98, s78
    v_perm_b32 v134, v102, v98, s79
    v_perm_b32 v131, v110, v106, s78
    v_perm_b32 v135, v110, v106, s79
    v_perm_b32 v136, v87, v83, s78
    v_perm_b32 v140, v87, v83, s79
    v_perm_b32 v137, v95, v91, s78
    v_perm_b32 v141, v95, v91, s79
    v_perm_b32 v138, v103, v99, s78
    v_perm_b32 v142, v103, v99, s79
    v_perm_b32 v139, v111, v107, s78
    v_perm_b32 v143, v111, v107, s79
    v_cmp_ne_u64 vcc, s[32:33], v[162:163]
    s_nop 3
    s_cbranch_vccz L_o_ml
    s_mov_b32 s80, 0
TP_83:
    buffer_load_dwordx4 v[160:163], v12, s[12:15], s68 offen offset:0 sc1
    s_waitcnt vmcnt(0)
    v_cmp_ne_u64 s[66:67], s[32:33], v[162:163]
    s_cmp_eq_u64 s[66:67], 0
    s_nop 2
    s_cbranch_scc1 TPD_84
    s_add_u32 s80, s80, 1
    s_cmp_gt_u32 s80, 100000
    s_cbranch_scc1 TPD_84
    s_sleep 4
    s_branch TP_83
TPD_84:
L_o_ml:
    s_mov_b32 s82, 0x3fb8aa3b
    v_max_f32_dpp v10, v160, v160 quad_perm:[1,0,3,2] row_mask:0xf bank_mask:0xf
    s_nop 1
    v_max_f32_dpp v10, v10, v10 quad_perm:[2,3,0,1] row_mask:0xf bank_mask:0xf
    s_nop 1
    v_max_f32_dpp v10, v10, v10 row_half_mirror row_mask:0xf bank_mask:0xf
    v_sub_f32 v10, v160, v10
    v_mul_f32 v10, s82, v10
    v_exp_f32 v10, v10
    s_nop 0
    v_mul_f32 v11, v10, v161
    s_nop 1
    v_add_f32_dpp v11, v11, v11 quad_perm:[1,0,3,2] row_mask:0xf bank_mask:0xf
    s_nop 1
    v_add_f32_dpp v11, v11, v11 quad_perm:[2,3,0,1] row_mask:0xf bank_mask:0xf
    s_nop 1
    v_add_f32_dpp v11, v11, v11 row_half_mirror row_mask:0xf bank_mask:0xf
    v_rcp_f32 v11, v11
    s_nop 0
    v_mul_f32 v10, v10, v11
    s_nop 1
    v_mov_b32_dpp v152, v10 row_newbcast:0 row_mask:0xf bank_mask:0xf
    v_mov_b32_dpp v153, v10 row_newbcast:1 row_mask:0xf bank_mask:0xf
    v_mov_b32_dpp v154, v10 row_newbcast:2 row_mask:0xf bank_mask:0xf
    v_mov_b32_dpp v155, v10 row_newbcast:3 row_mask:0xf bank_mask:0xf
    v_mov_b32_dpp v156, v10 row_newbcast:4 row_mask:0xf bank_mask:0xf
    v_mov_b32_dpp v157, v10 row_newbcast:5 row_mask:0xf bank_mask:0xf
    v_mov_b32_dpp v158, v10 row_newbcast:6 row_mask:0xf bank_mask:0xf
    v_mov_b32_dpp v159, v10 row_newbcast:7 row_mask:0xf bank_mask:0xf
    s_mov_b32 s80, 0
SP_85:
    ds_read_b32 v3, v0 offset:40
    s_waitcnt lgkmcnt(0)
    v_readfirstlane_b32 s81, v3
    s_cmp_ge_u32 s81, 1
    s_nop 2
    s_cbranch_scc1 SPD_86
    s_add_u32 s80, s80, 1
    s_cmp_gt_u32 s80, 100000
    s_cbranch_scc1 SPD_86
    s_sleep 2
    s_branch SP_85
SPD_86:
    s_mov_b32 s80, 0
    s_mov_b32 s82, 255
PL_87:
    s_bitcmp1_b32 s82, 0
    s_cbranch_scc0 PI_92
    buffer_load_dwordx4 v[16:19], v4, s[12:15], s72 offen offset:0 sc1
PI_92:
    s_bitcmp1_b32 s82, 1
    s_cbranch_scc0 PI_93
    buffer_load_dwordx4 v[20:23], v4, s[12:15], s72 offen offset:1024 sc1
PI_93:
    s_bitcmp1_b32 s82, 2
    s_cbranch_scc0 PI_94
    buffer_load_dwordx4 v[24:27], v4, s[12:15], s72 offen offset:2048 sc1
PI_94:
    s_bitcmp1_b32 s82, 3
    s_cbranch_scc0 PI_95
    buffer_load_dwordx4 v[28:31], v4, s[12:15], s72 offen offset:3072 sc1
PI_95:
    s_bitcmp1_b32 s82, 4
    s_cbranch_scc0 PI_96
    buffer_load_dwordx4 v[32:35], v4, s[12:15], s73 offen offset:0 sc1
PI_96:
    s_bitcmp1_b32 s82, 5
    s_cbranch_scc0 PI_97
    buffer_load_dwordx4 v[36:39], v4, s[12:15], s73 offen offset:1024 sc1
PI_97:
    s_bitcmp1_b32 s82, 6
    s_cbranch_scc0 PI_98
    buffer_load_dwordx4 v[40:43], v4, s[12:15], s73 offen offset:2048 sc1
PI_98:
    s_bitcmp1_b32 s82, 7
    s_cbranch_scc0 PI_99
    buffer_load_dwordx4 v[44:47], v4, s[12:15], s73 offen offset:3072 sc1
PI_99:
PW_89:
    s_mov_b32 s81, s82
    s_waitcnt vmcnt(0)
PW_91:
    s_bitcmp1_b32 s81, 0
    s_cbranch_scc0 PC_100
    v_cmp_u_f32 vcc, v16, v17
    v_cmp_u_f32 s[66:67], v18, v19
    s_or_b64 vcc, vcc, s[66:67]
    s_nop 2
    s_cbranch_scc1 PC_100
    s_bitset0_b32 s82, 0
    v_pk_fma_f32 v[166:167], v[18:19], v[152:153], v[166:167] op_sel_hi:[1,0,1]
    v_pk_fma_f32 v[164:165], v[16:17], v[152:153], v[164:165] op_sel_hi:[1,0,1]
PC_100:
    s_bitcmp1_b32 s81, 1
    s_cbranch_scc0 PC_101
    v_cmp_u_f32 vcc, v20, v21
    v_cmp_u_f32 s[66:67], v22, v23
    s_or_b64 vcc, vcc, s[66:67]
    s_nop 2
    s_cbranch_scc1 PC_101
    s_bitset0_b32 s82, 1
    v_pk_fma_f32 v[166:167], v[22:23], v[152:153], v[166:167] op_sel:[0,1,0] op_sel_hi:[1,1,1]
    v_pk_fma_f32 v[164:165], v[20:21], v[152:153], v[164:165] op_sel:[0,1,0] op_sel_hi:[1,1,1]
PC_101:
    s_bitcmp1_b32 s81, 2
    s_cbranch_scc0 PC_102
    v_cmp_u_f32 vcc, v24, v25
    v_cmp_u_f32 s[66:67], v26, v27
    s_or_b64 vcc, vcc, s[66:67]
    s_nop 2
    s_cbranch_scc1 PC_102
    s_bitset0_b32 s82, 2
    v_pk_fma_f32 v[166:167], v[26:27], v[154:155], v[166:167] op_sel_hi:[1,0,1]
    v_pk_fma_f32 v[164:165], v[24:25], v[154:155], v[164:165] op_sel_hi:[1,0,1]
PC_102:
    s_bitcmp1_b32 s81, 3
    s_cbranch_scc0 PC_103
    v_cmp_u_f32 vcc, v28, v29
    v_cmp_u_f32 s[66:67], v30, v31
    s_or_b64 vcc, vcc, s[66:67]
    s_nop 2
    s_cbranch_scc1 PC_103
    s_bitset0_b32 s82, 3
    v_pk_fma_f32 v[166:167], v[30:31], v[154:155], v[166:167] op_sel:[0,1,0] op_sel_hi:[1,1,1]
    v_pk_fma_f32 v[164:165], v[28:29], v[154:155], v[164:165] op_sel:[0,1,0] op_sel_hi:[1,1,1]
PC_103:
    s_bitcmp1_b32 s81, 4
    s_cbranch_scc0 PC_104
    v_cmp_u_f32 vcc, v32, v33
    v_cmp_u_f32 s[66:67], v34, v35
    s_or_b64 vcc, vcc, s[66:67]
    s_nop 2
    s_cbranch_scc1 PC_104
    s_bitset0_b32 s82, 4
    v_pk_fma_f32 v[166:167], v[34:35], v[156:157], v[166:167] op_sel_hi:[1,0,1]
    v_pk_fma_f32 v[164:165], v[32:33], v[156:157], v[164:165] op_sel_hi:[1,0,1]
PC_104:
    s_bitcmp1_b32 s81, 5
    s_cbranch_scc0 PC_105
    v_cmp_u_f32 vcc, v36, v37
    v_cmp_u_f32 s[66:67], v38, v39
    s_or_b64 vcc, vcc, s[66:67]
    s_nop 2
    s_cbranch_scc1 PC_105
    s_bitset0_b32 s82, 5
    v_pk_fma_f32 v[166:167], v[38:39], v[156:157], v[166:167] op_sel:[0,1,0] op_sel_hi:[1,1,1]
    v_pk_fma_f32 v[164:165], v[36:37], v[156:157], v[164:165] op_sel:[0,1,0] op_sel_hi:[1,1,1]
PC_105:
    s_bitcmp1_b32 s81, 6
    s_cbranch_scc0 PC_106
    v_cmp_u_f32 vcc, v40, v41
    v_cmp_u_f32 s[66:67], v42, v43
    s_or_b64 vcc, vcc, s[66:67]
    s_nop 2
    s_cbranch_scc1 PC_106
    s_bitset0_b32 s82, 6
    v_pk_fma_f32 v[166:167], v[42:43], v[158:159], v[166:167] op_sel_hi:[1,0,1]
    v_pk_fma_f32 v[164:165], v[40:41], v[158:159], v[164:165] op_sel_hi:[1,0,1]
PC_106:
    s_bitcmp1_b32 s81, 7
    s_cbranch_scc0 PC_107
    v_cmp_u_f32 vcc, v44, v45
    v_cmp_u_f32 s[66:67], v46, v47
    s_or_b64 vcc, vcc, s[66:67]
    s_nop 2
    s_cbranch_scc1 PC_107
    s_bitset0_b32 s82, 7
    v_pk_fma_f32 v[166:167], v[46:47], v[158:159], v[166:167] op_sel:[0,1,0] op_sel_hi:[1,1,1]
    v_pk_fma_f32 v[164:165], v[44:45], v[158:159], v[164:165] op_sel:[0,1,0] op_sel_hi:[1,1,1]
PC_107:
    s_cmp_eq_u32 s82, 0
    s_cbranch_scc1 PLD_88
    s_add_u32 s80, s80, 1
    s_cmp_gt_u32 s80, 100000
    s_cbranch_scc1 PLD_88
    s_bcnt1_i32_b32 s81, s82
    s_cmp_le_u32 s81, 3
    s_cbranch_scc1 PL_87
    s_sleep 0
    s_branch PL_87
PLD_88:
    v_cvt_pk_bf16_f32 v2, v164, v165
    v_cvt_pk_bf16_f32 v3, v166, v167
    ds_write_b64 v5, v[2:3]
    ds_read_b128 v[144:147], v6
    ds_read_b128 v[148:151], v6 offset:128
    s_waitcnt lgkmcnt(1)
    v_mfma_f32_16x16x32_bf16 v[16:19], v[144:147], v[48:51], 0
    v_mfma_f32_16x16x32_bf16 v[20:23], v[144:147], v[52:55], 0
    v_mfma_f32_16x16x32_bf16 v[24:27], v[144:147], v[56:59], 0
    v_mfma_f32_16x16x32_bf16 v[28:31], v[144:147], v[60:63], 0
    v_mfma_f32_16x16x32_bf16 v[32:35], v[144:147], v[64:67], 0
    v_mfma_f32_16x16x32_bf16 v[36:39], v[144:147], v[68:71], 0
    v_mfma_f32_16x16x32_bf16 v[40:43], v[144:147], v[72:75], 0
    v_mfma_f32_16x16x32_bf16 v[44:47], v[144:147], v[76:79], 0
    s_waitcnt lgkmcnt(0)
    v_mfma_f32_16x16x32_bf16 v[16:19], v[148:151], v[112:115], v[16:19]
    v_mfma_f32_16x16x32_bf16 v[20:23], v[148:151], v[116:119], v[20:23]
    v_mfma_f32_16x16x32_bf16 v[24:27], v[148:151], v[120:123], v[24:27]
    v_mfma_f32_16x16x32_bf16 v[28:31], v[148:151], v[124:127], v[28:31]
    v_mfma_f32_16x16x32_bf16 v[32:35], v[148:151], v[128:131], v[32:35]
    v_mfma_f32_16x16x32_bf16 v[36:39], v[148:151], v[132:135], v[36:39]
    v_mfma_f32_16x16x32_bf16 v[40:43], v[148:151], v[136:139], v[40:43]
    v_mfma_f32_16x16x32_bf16 v[44:47], v[148:151], v[140:143], v[44:47]
    s_mov_b32 exec_lo, 0xff0000ff
    s_mov_b32 exec_hi, 0
    ds_write2_b32 v7, v16, v20 offset0:0 offset1:1
    ds_write2_b32 v7, v17, v21 offset0:64 offset1:65
    ds_write2_b32 v7, v24, v28 offset0:2 offset1:3
    ds_write2_b32 v7, v25, v29 offset0:66 offset1:67
    ds_write2_b32 v7, v32, v36 offset0:4 offset1:5
    ds_write2_b32 v7, v33, v37 offset0:68 offset1:69
    ds_write2_b32 v7, v40, v44 offset0:6 offset1:7
    ds_write2_b32 v7, v41, v45 offset0:70 offset1:71
    s_mov_b64 exec, -1
    v_mov_b32 v2, 1
    s_mov_b64 exec, 1
    ds_add_rtn_u32 v2, v0, v2 offset:20
    s_mov_b64 exec, -1
    s_waitcnt lgkmcnt(0)
    v_readfirstlane_b32 s81, v2
    s_cmp_lg_u32 s81, 3
    s_nop 2
    s_cbranch_scc1 L_o_end
    ds_read_b64 v[48:49], v8 offset:9216
    ds_read_b64 v[50:51], v8 offset:9728
    ds_read_b64 v[52:53], v8 offset:10240
    ds_read_b64 v[54:55], v8 offset:10752
    ds_read_b64 v[56:57], v8 offset:11264
    ds_read_b64 v[58:59], v8 offset:11776
    ds_read_b64 v[60:61], v8 offset:12288
    ds_read_b64 v[62:63], v8 offset:12800
    s_waitcnt lgkmcnt(6)
    v_pk_add_f32 v[48:49], v[48:49], v[50:51]
    s_waitcnt lgkmcnt(4)
    v_pk_add_f32 v[52:53], v[52:53], v[54:55]
    s_waitcnt lgkmcnt(2)
    v_pk_add_f32 v[56:57], v[56:57], v[58:59]
    s_waitcnt lgkmcnt(0)
    v_pk_add_f32 v[60:61], v[60:61], v[62:63]
    v_pk_add_f32 v[48:49], v[48:49], v[52:53]
    v_pk_add_f32 v[56:57], v[56:57], v[60:61]
    v_pk_add_f32 v[48:49], v[48:49], v[56:57]
    v_cvt_pk_bf16_f32 v48, v48, v49
    buffer_store_dword v48, v9, s[12:15], s74 offen sc1
L_o_end:
L_t_none:
    s_endpgm
L_end:
    s_endpgm
    .p2align 2
L_table:
    .long 0x40102400, 0x40906400, 0x4110a400, 0x4190e400, 0x42112400, 0x42916400, 0x4311a400, 0x4391e400
    .long 0x40522500, 0x40d26500, 0x4152a500, 0x41d2e500, 0x42532500, 0x42d36500, 0x4353a500, 0x43d3e500
    .long 0x44142400, 0x44946400, 0x0514a400, 0x0594e400, 0x06152400, 0x06956400, 0x0715a300, 0x0795e300
    .long 0x04562300, 0x04d66300, 0x0556a300, 0x05d6e300, 0x06572300, 0x06d76300, 0x0757a300, 0x07d7e300
    .long 0x0818241e, 0x0898641e, 0x0918a41e, 0x0998e41e, 0x0a19241e, 0x0a99641e, 0x0b19a41e, 0x0b99e41e
    .long 0x085a241f, 0x08da641f, 0x095aa41f, 0x09dae41f, 0x0a5b241f, 0x0adb641f, 0x0b5ba41f, 0x0bdbe41f
    .long 0x0c1c241e, 0x0c9c641e, 0x0d1ca41e, 0x0d9ce41e, 0x0e1d241e, 0x0e9d641e, 0x0f10091d, 0x0f90091d
    .long 0x0c50091d, 0x0cd0091d, 0x0d50091d, 0x0dd0091d, 0x0e50091d, 0x0ed0091d, 0x0f50091d, 0x0fd0091d
    .long 0x1010093c, 0x1090093c, 0x1110093c, 0x1190093c, 0x1210093c, 0x1290093c, 0x1310093c, 0x1390093c
    .long 0x1050093d, 0x10d0093d, 0x1150093d, 0x11d0093d, 0x1250093d, 0x12d0093d, 0x1350093d, 0x13d0093d
    .long 0x1410093c, 0x1490093c, 0x1510093c, 0x1590093c, 0x1610093c, 0x1690093c, 0x17100940, 0x17900940
    .long 0x14500940, 0x14d00940, 0x15500940, 0x15d00940, 0x16500940, 0x16d00940, 0x17500940, 0x17d00940
    .long 0x1810095f, 0x1890095f, 0x1910095f, 0x1990095f, 0x1a10095f, 0x1a90095f, 0x1b10095f, 0x1b90095f
    .long 0x18500960, 0x18d00960, 0x19500960, 0x19d00960, 0x1a500960, 0x1ad00960, 0x1b500960, 0x1bd00960
    .long 0x1c10095f, 0x1c90095f, 0x1d10095f, 0x1d90095f, 0x1e10095f, 0x1e90095f, 0x1f100963, 0x1f900963
    .long 0x1c500963, 0x1cd00963, 0x1d500963, 0x1dd00963, 0x1e500963, 0x1ed00963, 0x1f500963, 0x1fd00963
    .long 0x02600882, 0x04a00882, 0x06e00882, 0x09200882, 0x0b600882, 0x0da00882, 0x0fe00882, 0x00200882
    .long 0x04e00883, 0x07200883, 0x09600883, 0x0ba00883, 0x0de00883, 0x10200883, 0x00600883, 0x02a00883
    .long 0x20100982, 0x20900982, 0x21100982, 0x21900982, 0x22100982, 0x22900982, 0x23100986, 0x23900986
    .long 0x20500986, 0x20d00986, 0x21500986, 0x21d00986, 0x22500986, 0x22d00986, 0x23500986, 0x23d00986
    .long 0x076008a4, 0x09a008a4, 0x0be008a4, 0x0e2008a4, 0x106008a4, 0x00a008a4, 0x02e008a4, 0x052008a4
    .long 0x09e008a5, 0x0c2008a5, 0x0e6008a5, 0x10a008a5, 0x00e008a5, 0x032008a5, 0x056008a5, 0x07a008a5
    .long 0x0c6008a5, 0x0ea008a5, 0x10e008a5, 0x012008a5, 0x036008a5, 0x05a008a5, 0x07e007a9, 0x0a2007a9
    .long 0x0ee007a9, 0x112007a9, 0x016007a9, 0x03a007a9, 0x05e007a9, 0x082007a9, 0x0a6007a9, 0x0ca007a9
    .long 0x400cd3c6, 0x400dd3c6, 0x400ed3c6, 0x400fd3c6, 0x4008d3c6, 0x4009d3c6, 0x400ad3c6, 0x400bd3c6
    .long 0x516d91c7, 0x41ae91c7, 0x43ef91c7, 0x462891c7, 0x486991c7, 0x4aaa91c7, 0x4ceb91c7, 0x4f2c91c7
    .long 0x442e51c7, 0x466f51c7, 0x48a851c7, 0x4ae951c7, 0x4d2a51c7, 0x4f6b51c7, 0x51ac50ca, 0x41ed50ca
    .long 0x46af10ca, 0x48e810ca, 0x4b2910ca, 0x4d6a10ca, 0x4fab10ca, 0x51ec10ca, 0x422d10ca, 0x446e10ca
    .long 0x400113e3, 0x400213e3, 0x400313e3, 0x400413e3, 0x400513e3, 0x400613e3, 0x400713e3, 0x400013e3
    .long 0x400254e2, 0x400354e2, 0x400454e2, 0x400554e2, 0x400654e2, 0x400754e2, 0x400054e2, 0x400154e2
    .long 0x400394e2, 0x400494e2, 0x400594e2, 0x400694e2, 0x400794e2, 0x400094e2, 0x400192e4, 0x400292e4
    .long 0x4004d2e4, 0x4005d2e4, 0x4006d2e4, 0x4007d2e4, 0x4000d2e4, 0x4001d2e4, 0x4002d2e4, 0x4003d2e4
.section .rodata,"a"
.p2align 6
.amdhsa_kernel adaLN_cond__gqa_block_cached__dense_activation_squared_relu__decode_kernel
  .amdhsa_next_free_vgpr 168
  .amdhsa_next_free_sgpr 102
  .amdhsa_accum_offset 168
  .amdhsa_group_segment_fixed_size 0
  .amdhsa_kernarg_size 120
  .amdhsa_user_sgpr_count 2
  .amdhsa_user_sgpr_kernarg_segment_ptr 1
  .amdhsa_system_sgpr_workgroup_id_x 1
  .amdhsa_float_denorm_mode_32 3
.end_amdhsa_kernel
```
